```python
import torch

def _softmax(x, axis=-1):
    return torch.softmax(x, dim=axis)

def _gelu(x):
    return torch.nn.functional.gelu(x, approximate='tanh')

def _silu(x):
    return torch.nn.functional.silu(x)

def _sigmoid(x):
    return torch.sigmoid(x)

def _layernorm(x, axis=-1, eps=1e-05):
    m = x.mean(dim=axis, keepdim=True)
    v = x.var(dim=axis, keepdim=True, unbiased=False)
    return (x - m) / torch.sqrt(v + eps)

def _scatter_add(tgt, idx, src, axis=0):
    return tgt.clone().index_add_(axis, idx, src)

def _segment_sum(src, seg, n):
    out = torch.zeros((n,) + src.shape[1:], dtype=src.dtype)
    return out.index_add_(0, seg, src)

def _pad(x, pw):
    flat = tuple((v for pair in reversed(pw) for v in pair))
    return torch.nn.functional.pad(x, flat)
kernel_name = 'adaLN_cond__gqa_block_cached__glu_gated_geglu__decode'

def setup_inputs():

    _w = lambda a: (lambda t: t.to(torch.bfloat16) if t.is_floating_point() else t)(torch.as_tensor(a))

    def _A_setup():
        B, Sq, D = (1, 1, 1024)
        Hq, Hkv, Sk, Dh = (32, 4, 65536, 128)
        assert Hq % Hkv == 0, (Hq, Hkv)
        return {'x': _w((lambda *s: torch.randn(*s, dtype=torch.bfloat16) * 0.05)(B, Sq, D)), 'k_cache': _w((lambda *s: torch.randn(*s, dtype=torch.bfloat16) * 3.2)(B, Hkv, Sk, Dh)), 'v_cache': _w((lambda *s: torch.randn(*s, dtype=torch.bfloat16) * 3.2)(B, Hkv, Sk, Dh)), 'wq': _w((lambda *s: torch.randn(*s, dtype=torch.bfloat16) * 3.2)(D, Hq * Dh) * D ** (-0.5)), 'wo': _w((lambda *s: torch.randn(*s, dtype=torch.bfloat16) * 3.2)(Hq * Dh, D) * (Hq * Dh) ** (-0.5))}
    _A_in = _A_setup()

    def _B_setup():
        B, S, Dm, Df = (1, 1, 1024, 3584)
        return {'x': _w((lambda *s: torch.randn(*s, dtype=torch.bfloat16) * 0.05)(B, S, Dm)), 'w_gate': _w((lambda *s: torch.randn(*s, dtype=torch.bfloat16) * 3.2)(Dm, Df) * Dm ** (-0.5)), 'w_up': _w((lambda *s: torch.randn(*s, dtype=torch.bfloat16) * 3.2)(Dm, Df) * Dm ** (-0.5)), 'w_down': _w((lambda *s: torch.randn(*s, dtype=torch.bfloat16) * 3.2)(Df, Dm) * Df ** (-0.5))}
    _B_in = _B_setup()
    return {'A_x': _A_in['x'], 'A_k_cache': _A_in['k_cache'], 'A_v_cache': _A_in['v_cache'], 'A_wq': _A_in['wq'], 'A_wo': _A_in['wo'], 'B_x': _B_in['x'], 'B_w_gate': _B_in['w_gate'], 'B_w_up': _B_in['w_up'], 'B_w_down': _B_in['w_down'], 'c': _w((lambda *s: torch.randn(*s, dtype=torch.bfloat16) * 0.4)(1, 1024) * 8.0), 'w_mod': _w((lambda *s: torch.randn(*s, dtype=torch.bfloat16) * 0.4)(1024, 6 * 1024) * 1024 ** (-0.5) * 8.0)}

def reference(A_x, A_k_cache, A_v_cache, A_wq, A_wo, B_x, B_w_gate, B_w_up, B_w_down, c, w_mod):

    def _A_ref(x, k_cache, v_cache, wq, wo):
        B, Sq, D = x.shape
        Hq, Dh = (32, 128)
        Hkv = k_cache.shape[1]
        rep = Hq // Hkv
        q = (lambda x, *d: x.permute(*d))((x @ wq).reshape(B, Sq, Hq, Dh), 0, 2, 1, 3)
        k = (lambda x, n, axis: torch.repeat_interleave(x, n, dim=axis))(k_cache, rep, axis=1)
        v = (lambda x, n, axis: torch.repeat_interleave(x, n, dim=axis))(v_cache, rep, axis=1)
        scores = torch.einsum('bhqd,bhkd->bhqk', q, k) * Dh ** (-0.5)
        p = _softmax(scores, axis=-1)
        o = torch.einsum('bhqk,bhkd->bhqd', p, v)
        return (lambda x, *d: x.permute(*d))(o, 0, 2, 1, 3).reshape(B, Sq, Hq * Dh) @ wo

    def _B_ref(x, w_gate, w_up, w_down):
        g = torch.einsum('bsd,df->bsf', x, w_gate)
        u = torch.einsum('bsd,df->bsf', x, w_up)
        h = _gelu(g) * u
        return torch.einsum('bsf,fd->bsd', h, w_down)
    x = A_x
    mod = (_silu(c) @ w_mod).reshape(c.shape[0], 6, 1, -1)
    sa, ca, ga, sb, cb, gb = (mod[:, 0].clone(), mod[:, 1].clone(), mod[:, 2].clone(), mod[:, 3].clone(), mod[:, 4].clone(), mod[:, 5].clone())
    h = _layernorm(x, axis=-1) * (1 + ca) + sa
    x = x + ga * _A_ref(h, A_k_cache, A_v_cache, A_wq, A_wo)
    h = _layernorm(x, axis=-1) * (1 + cb) + sb
    x = x + gb * _B_ref(h, B_w_gate, B_w_up, B_w_down)
    return x
```

```asm
; @launch grid=(256,1,1) block=(384,1,1) lds=159744
.amdgcn_target "amdgcn-amd-amdhsa--gfx950"
.text
.globl adaLN_cond__gqa_block_cached__glu_gated_geglu__decode_kernel
.p2align 8
.type adaLN_cond__gqa_block_cached__glu_gated_geglu__decode_kernel,@function
adaLN_cond__gqa_block_cached__glu_gated_geglu__decode_kernel:
    s_cmp_ge_u32 s2, 256
    s_cbranch_scc1 L_done
    s_load_dwordx16 s[16:31], s[0:1], 0
    s_load_dwordx8 s[32:39], s[0:1], 64
    s_load_dwordx4 s[40:43], s[0:1], 96
    v_lshrrev_b32 v1, 6, v0
    v_and_b32 v0, 63, v0
    v_readfirstlane_b32 s3, v1
    s_and_b32 s10, s2, 7
    s_lshr_b32 s11, s2, 6
    s_bfe_u32 s12, s2, 0x30003
    s_mul_i32 s13, s11, 3
    s_add_u32 s13, s13, s12
    s_sub_u32 s13, s13, 4
    s_lshr_b32 s14, s13, 1
    s_mul_i32 s4, s10, 6
    s_add_u32 s4, s4, s14
    s_add_u32 s14, s4, 4
    s_mul_i32 s14, s14, 37
    s_lshr_b32 s14, s14, 8
    s_add_u32 s4, s4, s14
    s_lshl_b32 s4, s4, 1
    s_and_b32 s13, s13, 1
    s_add_u32 s4, s4, s13
    s_lshl4_add_u32 s13, s10, 6
    s_min_u32 s13, s13, 110
    s_lshr_b32 s14, s11, 1
    s_add_u32 s13, s13, s14
    s_lshr_b32 s14, s10, 2
    s_xor_b32 s14, s14, s11
    s_and_b32 s14, s14, 1
    s_cselect_b32 s9, 2, 1
    s_cmp_eq_u32 s12, 7
    s_cselect_b32 s4, s13, s4
    s_cselect_b32 s9, s9, 1
    s_lshl3_add_u32 s13, s11, s10
    s_lshl2_add_u32 s13, s13, s12
    s_cmp_lt_u32 s12, 4
    s_cselect_b32 s4, s13, s4
    s_cselect_b32 s9, 0, s9
    s_mov_b32 s5, 4000000
    s_mov_b64 s[100:101], -1
    v_mov_b32 v1, 147456
    s_lshr_b32 s13, s9, 1
    s_or_b32 s13, s13, s3
    s_cbranch_scc1 L_other
    s_setprio 2
    s_mov_b32 s58, 0
    s_mov_b32 s60, 0
    s_mov_b32 s61, 0
    s_mov_b32 s62, 0
    v_mov_b32 v12, 0
    v_mov_b32 v13, -1
    v_mov_b32 v14, 0
    ds_write_b96 v1, v[12:14] offset:0
    s_and_b32 s64, s4, 3
    s_lshr_b32 s65, s4, 2
    s_lshl_b32 s66, s65, 8
    s_lshl_b32 s65, s65, 7
    s_mul_i32 s52, s64, 3145728
    s_add_u32 s52, s52, s65
    s_lshl_b32 s13, s4, 6
    s_movk_i32 s14, 12288
    s_cmp_eq_u32 s9, 0
    s_cselect_b32 s52, s52, s13
    s_cselect_b32 s14, s14, 7168
    s_cselect_b32 s10, 3, 2
    s_cselect_b32 s11, 7, 3
    s_cselect_b32 s12, 3, 4
    s_lshl_b32 s50, s14, 10
    s_mov_b32 s51, 0x20000
    s_lshl_b32 s53, s14, s12
    s_add_u32 s54, s53, 3072
    s_sub_u32 s53, s53, 1024
    v_lshrrev_b32 v2, s10, v0
    v_lshrrev_b32 v3, 3, v0
    v_and_b32 v3, 6, v3
    v_xor_b32 v3, v3, v0
    v_and_b32 v3, s11, v3
    v_lshlrev_b32 v3, 4, v3
    v_mad_u32_u24 v4, v2, s14, v3
    s_mov_b32 m0, 0
    s_cmp_eq_u32 s9, 0
    s_waitcnt lgkmcnt(0)
    s_cselect_b64 s[48:49], s[36:37], s[28:29]
L_first:
    buffer_load_dwordx4 v4, s[48:51], s52 offen offset:0 nt lds
    s_add_u32 s52, s52, s53
    buffer_load_dwordx4 v4, s[48:51], s52 offen offset:1024 nt lds
    s_add_u32 s52, s52, s53
    buffer_load_dwordx4 v4, s[48:51], s52 offen offset:2048 nt lds
    s_add_u32 s52, s52, s53
    buffer_load_dwordx4 v4, s[48:51], s52 offen offset:3072 nt lds
    s_add_u32 s52, s52, s54
    s_add_u32 m0, m0, 4096
    s_sub_u32 s11, s11, 1
    s_cbranch_scc0 L_first
    s_cmp_eq_u32 s9, 1
    s_cbranch_scc1 L_ld_A
    s_branch L_ld_go
L_other:
    s_cmp_lg_u32 s9, 2
    s_cbranch_scc1 L_nocpf
    s_getpc_b64 s[12:13]
L_pc:
    s_lshl_b32 s14, s3, 12
    v_lshlrev_b32 v2, 6, v0
    v_add_u32 v2, s14, v2
    v_min_u32 v2, L_done-L_pc, v2
    global_load_dword v255, v2, s[12:13]
L_nocpf:
    s_waitcnt lgkmcnt(0)
    s_mov_b32 s44, s42
    s_mov_b32 s45, s43
    s_mov_b32 s46, 0x10000000
    s_mov_b32 s47, 0x20000
    s_cmp_eq_u32 s3, 5
    s_cbranch_scc1 L_service
    s_cmp_lg_u32 s3, 0
    s_cbranch_scc1 L_bar
    s_setprio 2
    s_mov_b32 s58, 0
    s_mov_b32 s60, 0
    s_mov_b32 s61, 0
    s_mov_b32 s62, 0
    v_mov_b32 v12, 0
    v_mov_b32 v13, -1
    v_mov_b32 v14, 0
    ds_write_b96 v1, v[12:14] offset:0
    s_waitcnt lgkmcnt(0)
L_bar:
    s_barrier
    s_cbranch_scc1 L_consumer
    s_branch L_ld_kv
L_service:
    s_setprio 3
    v_lshl_add_u32 v7, v0, 2, v1
    v_mov_b32 v8, 0
    s_mov_b64 exec, 0x1fffffff
    ds_write_b32 v7, v8 offset:12
    s_mov_b64 exec, -1
    s_mov_b32 s48, s34
    s_mov_b32 s49, s35
    s_mov_b32 s50, 0x800
    s_mov_b32 s51, 0x20000
    s_mov_b32 s52, s16
    s_mov_b32 s53, s17
    s_mov_b32 s54, 0x800
    s_mov_b32 s55, 0x20000
    s_mov_b32 s56, s38
    s_mov_b32 s57, s39
    s_mov_b32 s58, 0x800
    s_mov_b32 s59, 0x20000
    v_lshlrev_b32 v2, 2, v0
    v_lshlrev_b32 v3, 4, v0
    s_waitcnt lgkmcnt(0)
    buffer_load_dwordx2 v[118:119], v8, s[44:47], 0 offen sc1
    s_and_b32 s64, s4, 3
    s_lshl_b32 s65, s64, 9
    s_cmp_lg_u32 s9, 0
    s_cbranch_scc1 L_s_noin
    v_lshlrev_b32 v13, 3, v0
    buffer_load_dwordx2 v[128:129], v13, s[48:51], s65 offen
    buffer_load_dwordx2 v[136:137], v13, s[52:55], s65 offen
    s_add_u32 s65, s65, 512
    s_and_b32 s65, s65, 2047
    buffer_load_dwordx2 v[138:139], v13, s[52:55], s65 offen
    s_add_u32 s65, s65, 512
    s_and_b32 s65, s65, 2047
    buffer_load_dwordx2 v[140:141], v13, s[52:55], s65 offen
    s_add_u32 s65, s65, 512
    s_and_b32 s65, s65, 2047
    buffer_load_dwordx2 v[142:143], v13, s[52:55], s65 offen
    s_add_u32 s65, s65, 512
    s_and_b32 s65, s65, 2047
L_s_noin:
    v_and_b32 v6, 7, v0
    v_lshrrev_b32 v10, 3, v0
    v_mul_u32_u24 v5, 12288, v10
    v_lshl_add_u32 v5, v6, 4, v5
    v_lshlrev_b32 v10, 2, v10
    v_lshl_add_u32 v11, v6, 3, v1
    v_lshlrev_b32 v12, 4, v6
    v_lshlrev_b32 v6, 3, v6
    v_lshl_add_u32 v9, v0, 3, v1
    s_getreg_b32 s14, hwreg(HW_REG_XCC_ID)
    s_and_b32 s14, s14, 7
    s_mul_i32 s14, s14, 12288
    s_add_u32 s14, s14, 262144
    s_mov_b32 s74, 0x3fb8aa3b
    s_mov_b32 s15, 0
    s_barrier
    s_cmp_lg_u32 s9, 0
    s_cbranch_scc1 L_s_notB
    s_waitcnt vmcnt(4)
    v_add_u32 v118, 1, v118
    v_readfirstlane_b32 s7, v119
    v_readfirstlane_b32 s6, v118
    ds_write_b64 v1, v[118:119] offset:128
    v_lshlrev_b32 v16, 16, v128
    v_and_b32 v17, 0xffff0000, v128
    v_lshlrev_b32 v18, 16, v129
    v_and_b32 v19, 0xffff0000, v129
    v_mul_f32 v32, s74, v16
    v_mul_f32 v33, s74, v17
    v_mul_f32 v34, s74, v18
    v_mul_f32 v35, s74, v19
    v_fma_f32 v36, v16, s74, -v32
    v_fma_f32 v37, v17, s74, -v33
    v_fma_f32 v38, v18, s74, -v34
    v_fma_f32 v39, v19, s74, -v35
    v_fmac_f32 v36, 0x32a57060, v16
    v_fmac_f32 v37, 0x32a57060, v17
    v_fmac_f32 v38, 0x32a57060, v18
    v_fmac_f32 v39, 0x32a57060, v19
    v_exp_f32 v32, -v32
    v_exp_f32 v33, -v33
    v_exp_f32 v34, -v34
    v_exp_f32 v35, -v35
    v_mul_f32 v36, 0xbf317218, v36
    v_mul_f32 v37, 0xbf317218, v37
    v_mul_f32 v38, 0xbf317218, v38
    v_mul_f32 v39, 0xbf317218, v39
    v_min_f32 v32, 0x7f7fffff, v32
    v_min_f32 v33, 0x7f7fffff, v33
    v_min_f32 v34, 0x7f7fffff, v34
    v_min_f32 v35, 0x7f7fffff, v35
    v_fmac_f32 v32, v32, v36
    v_fmac_f32 v33, v33, v37
    v_fmac_f32 v34, v34, v38
    v_fmac_f32 v35, v35, v39
    v_add_f32 v32, 1.0, v32
    v_add_f32 v33, 1.0, v33
    v_add_f32 v34, 1.0, v34
    v_add_f32 v35, 1.0, v35
    v_min_f32 v32, 0x7e000000, v32
    v_min_f32 v33, 0x7e000000, v33
    v_min_f32 v34, 0x7e000000, v34
    v_min_f32 v35, 0x7e000000, v35
    v_rcp_f32 v36, v32
    v_rcp_f32 v37, v33
    v_rcp_f32 v38, v34
    v_rcp_f32 v39, v35
    v_mul_f32 v40, v16, v36
    v_mul_f32 v41, v17, v37
    v_mul_f32 v42, v18, v38
    v_mul_f32 v43, v19, v39
    v_fma_f32 v16, -v40, v32, v16
    v_fma_f32 v17, -v41, v33, v17
    v_fma_f32 v18, -v42, v34, v18
    v_fma_f32 v19, -v43, v35, v19
    v_fma_f32 v16, v16, v36, v40
    v_fma_f32 v17, v17, v37, v41
    v_fma_f32 v18, v18, v38, v42
    v_fma_f32 v19, v19, v39, v43
    v_cvt_pk_bf16_f32 v32, v16, v17
    v_cvt_pk_bf16_f32 v33, v18, v19
    ds_write_b64 v9, v[32:33] offset:4096
    v_mov_b32 v14, 1
    ds_write_b32 v1, v14 offset:48
    s_and_b32 s65, s4, 31
    s_cmp_lg_u32 s65, 0
    s_cbranch_scc1 L_s_nocnt
    s_lshr_b32 s65, s4, 5
    s_mul_i32 s65, s65, 34816
    s_add_u32 s65, s65, 655360
    v_mul_u32_u24 v13, 4352, v0
    s_mov_b64 exec, 0xff
    buffer_store_dword v8, v13, s[44:47], s65 offen sc1
    s_mov_b64 exec, -1
L_s_nocnt:
    s_waitcnt vmcnt(1)
    s_waitcnt vmcnt(0)
    v_add_u32 v4, v3, v1
    s_lshr_b32 s65, s4, 2
    s_mul_i32 s88, s64, 24576
    s_add_u32 s88, s88, 65536
    s_lshl_b32 s89, s65, 9
    s_add_u32 s90, s88, s89
    s_add_u32 s90, s90, 8192
    s_lshl_b32 s65, s65, 8
    s_add_u32 s88, s88, s65
    s_mul_i32 s65, s64, 16384
    s_add_u32 s89, s89, s65
    s_add_u32 s89, s89, 163840
    v_lshlrev_b32 v16, 16, v136
    v_and_b32 v17, 0xffff0000, v136
    v_lshlrev_b32 v18, 16, v137
    v_and_b32 v19, 0xffff0000, v137
    v_lshlrev_b32 v20, 16, v138
    v_and_b32 v21, 0xffff0000, v138
    v_lshlrev_b32 v22, 16, v139
    v_and_b32 v23, 0xffff0000, v139
    v_lshlrev_b32 v24, 16, v140
    v_and_b32 v25, 0xffff0000, v140
    v_lshlrev_b32 v26, 16, v141
    v_and_b32 v27, 0xffff0000, v141
    v_lshlrev_b32 v28, 16, v142
    v_and_b32 v29, 0xffff0000, v142
    v_lshlrev_b32 v30, 16, v143
    v_and_b32 v31, 0xffff0000, v143
    v_pk_add_f32 v[32:33], v[16:17], v[24:25]
    v_pk_add_f32 v[34:35], v[18:19], v[26:27]
    v_pk_add_f32 v[36:37], v[20:21], v[28:29]
    v_pk_add_f32 v[38:39], v[22:23], v[30:31]
    v_pk_add_f32 v[32:33], v[32:33], v[34:35]
    v_pk_add_f32 v[36:37], v[36:37], v[38:39]
    v_pk_add_f32 v[32:33], v[32:33], v[36:37]
    v_add_f32 v48, v32, v33
    s_nop 1
    v_add_f32_dpp v48, v48, v48 quad_perm:[1,0,3,2] row_mask:0xf bank_mask:0xf
    s_nop 1
    v_add_f32_dpp v48, v48, v48 quad_perm:[2,3,0,1] row_mask:0xf bank_mask:0xf
    s_nop 1
    v_add_f32_dpp v48, v48, v48 row_half_mirror row_mask:0xf bank_mask:0xf
    s_nop 1
    v_add_f32_dpp v48, v48, v48 row_mirror row_mask:0xf bank_mask:0xf
    v_mov_b32 v49, v48
    s_nop 1
    v_permlane16_swap_b32 v48, v49
    v_add_f32 v48, v48, v49
    v_mov_b32 v49, v48
    s_nop 1
    v_permlane32_swap_b32 v48, v49
    v_add_f32 v48, v48, v49
    v_mul_f32 v48, 0x3a800000, v48
    v_pk_add_f32 v[32:33], v[16:17], v[48:49] op_sel_hi:[1,0] neg_lo:[0,1] neg_hi:[0,1]
    v_pk_add_f32 v[34:35], v[18:19], v[48:49] op_sel_hi:[1,0] neg_lo:[0,1] neg_hi:[0,1]
    v_pk_add_f32 v[36:37], v[20:21], v[48:49] op_sel_hi:[1,0] neg_lo:[0,1] neg_hi:[0,1]
    v_pk_add_f32 v[38:39], v[22:23], v[48:49] op_sel_hi:[1,0] neg_lo:[0,1] neg_hi:[0,1]
    v_pk_add_f32 v[40:41], v[24:25], v[48:49] op_sel_hi:[1,0] neg_lo:[0,1] neg_hi:[0,1]
    v_pk_add_f32 v[42:43], v[26:27], v[48:49] op_sel_hi:[1,0] neg_lo:[0,1] neg_hi:[0,1]
    v_pk_add_f32 v[44:45], v[28:29], v[48:49] op_sel_hi:[1,0] neg_lo:[0,1] neg_hi:[0,1]
    v_pk_add_f32 v[46:47], v[30:31], v[48:49] op_sel_hi:[1,0] neg_lo:[0,1] neg_hi:[0,1]
    v_pk_mul_f32 v[50:51], v[32:33], v[32:33]
    v_pk_fma_f32 v[50:51], v[34:35], v[34:35], v[50:51]
    v_pk_fma_f32 v[50:51], v[36:37], v[36:37], v[50:51]
    v_pk_fma_f32 v[50:51], v[38:39], v[38:39], v[50:51]
    v_pk_fma_f32 v[50:51], v[40:41], v[40:41], v[50:51]
    v_pk_fma_f32 v[50:51], v[42:43], v[42:43], v[50:51]
    v_pk_fma_f32 v[50:51], v[44:45], v[44:45], v[50:51]
    v_pk_fma_f32 v[50:51], v[46:47], v[46:47], v[50:51]
    v_add_f32 v50, v50, v51
    s_nop 1
    v_add_f32_dpp v50, v50, v50 quad_perm:[1,0,3,2] row_mask:0xf bank_mask:0xf
    s_nop 1
    v_add_f32_dpp v50, v50, v50 quad_perm:[2,3,0,1] row_mask:0xf bank_mask:0xf
    s_nop 1
    v_add_f32_dpp v50, v50, v50 row_half_mirror row_mask:0xf bank_mask:0xf
    s_nop 1
    v_add_f32_dpp v50, v50, v50 row_mirror row_mask:0xf bank_mask:0xf
    v_mov_b32 v51, v50
    s_nop 1
    v_permlane16_swap_b32 v50, v51
    v_add_f32 v50, v50, v51
    v_mov_b32 v51, v50
    s_nop 1
    v_permlane32_swap_b32 v50, v51
    v_add_f32 v50, v50, v51
    v_mul_f32 v50, 0x3a800000, v50
    v_cvt_pk_bf16_f32 v48, v48, v48
    v_and_b32 v48, 0xffff0000, v48
    v_cvt_pk_bf16_f32 v50, v50, v50
    v_and_b32 v50, 0xffff0000, v50
    v_add_f32 v50, 0x3727c5ac, v50
    v_cvt_pk_bf16_f32 v50, v50, v50
    v_and_b32 v50, 0xffff0000, v50
    v_sqrt_f32 v50, v50
    s_nop 0
    v_cvt_pk_bf16_f32 v50, v50, v50
    v_and_b32 v50, 0xffff0000, v50
    v_rcp_f32 v51, v50
    v_pk_add_f32 v[16:17], v[16:17], v[48:49] op_sel_hi:[1,0] neg_lo:[0,1] neg_hi:[0,1]
    v_pk_add_f32 v[18:19], v[18:19], v[48:49] op_sel_hi:[1,0] neg_lo:[0,1] neg_hi:[0,1]
    v_cvt_pk_bf16_f32 v17, v16, v17
    v_cvt_pk_bf16_f32 v19, v18, v19
    v_lshlrev_b32 v16, 16, v17
    v_and_b32 v17, 0xffff0000, v17
    v_lshlrev_b32 v18, 16, v19
    v_and_b32 v19, 0xffff0000, v19
    v_pk_mul_f32 v[32:33], v[16:17], v[50:51] op_sel:[0,1] op_sel_hi:[1,1]
    v_pk_mul_f32 v[34:35], v[18:19], v[50:51] op_sel:[0,1] op_sel_hi:[1,1]
    v_pk_fma_f32 v[16:17], v[32:33], v[50:51], v[16:17] op_sel_hi:[1,0,1] neg_lo:[1,0,0] neg_hi:[1,0,0]
    v_pk_fma_f32 v[18:19], v[34:35], v[50:51], v[18:19] op_sel_hi:[1,0,1] neg_lo:[1,0,0] neg_hi:[1,0,0]
    v_pk_fma_f32 v[16:17], v[16:17], v[50:51], v[32:33] op_sel:[0,1,0] op_sel_hi:[1,1,1]
    v_pk_fma_f32 v[18:19], v[18:19], v[50:51], v[34:35] op_sel:[0,1,0] op_sel_hi:[1,1,1]
    v_cvt_pk_bf16_f32 v17, v16, v17
    v_cvt_pk_bf16_f32 v19, v18, v19
    v_lshlrev_b32 v16, 16, v17
    v_and_b32 v17, 0xffff0000, v17
    v_lshlrev_b32 v18, 16, v19
    v_and_b32 v19, 0xffff0000, v19
    s_bfe_u32 s84, s6, 0x30000
    s_bfe_u32 s85, s6, 0x30003
    s_bfe_u32 s86, s6, 0x30006
    s_bfe_u32 s87, s6, 0x30009
    s_branch Lh_2
Lr_1:
    s_sub_u32 s5, s5, 1
    s_cbranch_scc1 L_done
Lh_2:
    ds_read_b128 v[100:103], v1 offset:32
    ds_read_b128 v[104:107], v4 offset:256
    s_waitcnt lgkmcnt(1)
    v_min3_u32 v100, v100, v101, v102
    v_min_u32 v100, v100, v103
    v_cmp_gt_u32 vcc, 1, v100
    s_cbranch_vccnz Lr_1
    s_waitcnt lgkmcnt(0)
    v_add_u32 v104, 4, v104
    v_add_u32 v105, 4, v105
    v_add_u32 v106, 4, v106
    v_add_u32 v107, 4, v107
    v_and_or_b32 v104, v104, -8, s84
    v_and_or_b32 v105, v105, -8, s85
    v_and_or_b32 v106, v106, -8, s86
    v_and_or_b32 v107, v107, -8, s87
    s_and_b32 exec_lo, exec_lo, 0xffff
    s_mov_b32 exec_hi, 0
    s_cbranch_execz Lx_3
    buffer_store_dwordx4 v[104:107], v3, s[44:47], s88 offen sc1
Lx_3:
    s_mov_b64 exec, s[100:101]
    s_lshl_b32 s65, s64, 10
    s_add_u32 s76, s65, 65536
    s_add_u32 s77, s76, 24576
    s_add_u32 s78, s76, 49152
    s_add_u32 s79, s76, 73728
    s_add_u32 s80, s76, 4096
    s_add_u32 s81, s76, 28672
    s_add_u32 s82, s76, 53248
    s_add_u32 s83, s76, 77824
    s_branch Lh_5
Lr_4:
    s_sub_u32 s5, s5, 1
    s_cbranch_scc1 L_done
Lh_5:
    ds_read_b32 v14, v1 offset:0
    s_waitcnt lgkmcnt(0)
    v_cmp_gt_u32 vcc, 5, v14
    s_cbranch_vccnz Lr_4
    s_cbranch_execz Lx_9
    buffer_load_dwordx4 v[128:131], v3, s[44:47], s76 offen offset:0 sc1
    buffer_load_dwordx4 v[132:135], v3, s[44:47], s77 offen offset:0 sc1
    buffer_load_dwordx4 v[136:139], v3, s[44:47], s78 offen offset:0 sc1
    buffer_load_dwordx4 v[140:143], v3, s[44:47], s79 offen offset:0 sc1
    buffer_load_dwordx4 v[144:147], v3, s[44:47], s80 offen offset:0 sc1
    buffer_load_dwordx4 v[148:151], v3, s[44:47], s81 offen offset:0 sc1
    buffer_load_dwordx4 v[152:155], v3, s[44:47], s82 offen offset:0 sc1
    buffer_load_dwordx4 v[156:159], v3, s[44:47], s83 offen offset:0 sc1
Lx_9:
    s_branch Lc_7
Lg_6:
    s_mov_b64 exec, s[16:17]
    s_cbranch_execz Ls_10
    buffer_load_dwordx4 v[128:131], v3, s[44:47], s76 offen offset:0 sc1
Ls_10:
    s_mov_b64 exec, s[18:19]
    s_cbranch_execz Ls_11
    buffer_load_dwordx4 v[132:135], v3, s[44:47], s77 offen offset:0 sc1
Ls_11:
    s_mov_b64 exec, s[20:21]
    s_cbranch_execz Ls_12
    buffer_load_dwordx4 v[136:139], v3, s[44:47], s78 offen offset:0 sc1
Ls_12:
    s_mov_b64 exec, s[22:23]
    s_cbranch_execz Ls_13
    buffer_load_dwordx4 v[140:143], v3, s[44:47], s79 offen offset:0 sc1
Ls_13:
    s_mov_b64 exec, s[24:25]
    s_cbranch_execz Ls_14
    buffer_load_dwordx4 v[144:147], v3, s[44:47], s80 offen offset:0 sc1
Ls_14:
    s_mov_b64 exec, s[26:27]
    s_cbranch_execz Ls_15
    buffer_load_dwordx4 v[148:151], v3, s[44:47], s81 offen offset:0 sc1
Ls_15:
    s_mov_b64 exec, s[28:29]
    s_cbranch_execz Ls_16
    buffer_load_dwordx4 v[152:155], v3, s[44:47], s82 offen offset:0 sc1
Ls_16:
    s_mov_b64 exec, s[30:31]
    s_cbranch_execz Ls_17
    buffer_load_dwordx4 v[156:159], v3, s[44:47], s83 offen offset:0 sc1
Ls_17:
    s_mov_b64 exec, -1
Lc_7:
    s_waitcnt vmcnt(0)
    v_xor_b32 v100, s84, v128
    v_bitop3_b32 v100, v129, s85, v100 bitop3:0xbe
    v_bitop3_b32 v100, v130, s86, v100 bitop3:0xbe
    v_bitop3_b32 v100, v131, s87, v100 bitop3:0xbe
    v_xor_b32 v101, s84, v132
    v_bitop3_b32 v101, v133, s85, v101 bitop3:0xbe
    v_bitop3_b32 v101, v134, s86, v101 bitop3:0xbe
    v_bitop3_b32 v101, v135, s87, v101 bitop3:0xbe
    v_xor_b32 v102, s84, v136
    v_bitop3_b32 v102, v137, s85, v102 bitop3:0xbe
    v_bitop3_b32 v102, v138, s86, v102 bitop3:0xbe
    v_bitop3_b32 v102, v139, s87, v102 bitop3:0xbe
    v_xor_b32 v103, s84, v140
    v_bitop3_b32 v103, v141, s85, v103 bitop3:0xbe
    v_bitop3_b32 v103, v142, s86, v103 bitop3:0xbe
    v_bitop3_b32 v103, v143, s87, v103 bitop3:0xbe
    v_or_b32_dpp v100, v100, v100 quad_perm:[1,0,3,2] row_mask:0xf bank_mask:0xf
    v_or_b32_dpp v101, v101, v101 quad_perm:[1,0,3,2] row_mask:0xf bank_mask:0xf
    v_or_b32_dpp v102, v102, v102 quad_perm:[1,0,3,2] row_mask:0xf bank_mask:0xf
    v_or_b32_dpp v103, v103, v103 quad_perm:[1,0,3,2] row_mask:0xf bank_mask:0xf
    v_or_b32_dpp v100, v100, v100 quad_perm:[2,3,0,1] row_mask:0xf bank_mask:0xf
    v_or_b32_dpp v101, v101, v101 quad_perm:[2,3,0,1] row_mask:0xf bank_mask:0xf
    v_or_b32_dpp v102, v102, v102 quad_perm:[2,3,0,1] row_mask:0xf bank_mask:0xf
    v_or_b32_dpp v103, v103, v103 quad_perm:[2,3,0,1] row_mask:0xf bank_mask:0xf
    v_and_b32 v100, 7, v100
    v_cmp_ne_u32 s[16:17], 0, v100
    v_and_b32 v101, 7, v101
    v_cmp_ne_u32 s[18:19], 0, v101
    v_and_b32 v102, 7, v102
    v_cmp_ne_u32 s[20:21], 0, v102
    v_and_b32 v103, 7, v103
    v_cmp_ne_u32 s[22:23], 0, v103
    v_xor_b32 v100, s84, v144
    v_bitop3_b32 v100, v145, s85, v100 bitop3:0xbe
    v_bitop3_b32 v100, v146, s86, v100 bitop3:0xbe
    v_bitop3_b32 v100, v147, s87, v100 bitop3:0xbe
    v_xor_b32 v101, s84, v148
    v_bitop3_b32 v101, v149, s85, v101 bitop3:0xbe
    v_bitop3_b32 v101, v150, s86, v101 bitop3:0xbe
    v_bitop3_b32 v101, v151, s87, v101 bitop3:0xbe
    v_xor_b32 v102, s84, v152
    v_bitop3_b32 v102, v153, s85, v102 bitop3:0xbe
    v_bitop3_b32 v102, v154, s86, v102 bitop3:0xbe
    v_bitop3_b32 v102, v155, s87, v102 bitop3:0xbe
    v_xor_b32 v103, s84, v156
    v_bitop3_b32 v103, v157, s85, v103 bitop3:0xbe
    v_bitop3_b32 v103, v158, s86, v103 bitop3:0xbe
    v_bitop3_b32 v103, v159, s87, v103 bitop3:0xbe
    v_or_b32_dpp v100, v100, v100 quad_perm:[1,0,3,2] row_mask:0xf bank_mask:0xf
    v_or_b32_dpp v101, v101, v101 quad_perm:[1,0,3,2] row_mask:0xf bank_mask:0xf
    v_or_b32_dpp v102, v102, v102 quad_perm:[1,0,3,2] row_mask:0xf bank_mask:0xf
    v_or_b32_dpp v103, v103, v103 quad_perm:[1,0,3,2] row_mask:0xf bank_mask:0xf
    v_or_b32_dpp v100, v100, v100 quad_perm:[2,3,0,1] row_mask:0xf bank_mask:0xf
    v_or_b32_dpp v101, v101, v101 quad_perm:[2,3,0,1] row_mask:0xf bank_mask:0xf
    v_or_b32_dpp v102, v102, v102 quad_perm:[2,3,0,1] row_mask:0xf bank_mask:0xf
    v_or_b32_dpp v103, v103, v103 quad_perm:[2,3,0,1] row_mask:0xf bank_mask:0xf
    v_and_b32 v100, 7, v100
    v_cmp_ne_u32 s[24:25], 0, v100
    v_and_b32 v101, 7, v101
    v_cmp_ne_u32 s[26:27], 0, v101
    v_and_b32 v102, 7, v102
    v_cmp_ne_u32 s[28:29], 0, v102
    v_and_b32 v103, 7, v103
    v_cmp_ne_u32 s[30:31], 0, v103
    s_mov_b64 s[12:13], s[16:17]
    s_or_b64 s[12:13], s[12:13], s[18:19]
    s_or_b64 s[12:13], s[12:13], s[20:21]
    s_or_b64 s[12:13], s[12:13], s[22:23]
    s_or_b64 s[12:13], s[12:13], s[24:25]
    s_or_b64 s[12:13], s[12:13], s[26:27]
    s_or_b64 s[12:13], s[12:13], s[28:29]
    s_or_b64 s[12:13], s[12:13], s[30:31]
    s_cmp_eq_u64 s[12:13], 0
    s_cbranch_scc1 Ld_8
    s_sub_u32 s5, s5, 16
    s_cbranch_scc0 Lg_6
    s_branch L_done
Ld_8:
    v_and_b32 v128, -8, v128
    v_and_b32 v129, -8, v129
    v_and_b32 v130, -8, v130
    v_and_b32 v131, -8, v131
    v_and_b32 v132, -8, v132
    v_and_b32 v133, -8, v133
    v_and_b32 v134, -8, v134
    v_and_b32 v135, -8, v135
    v_and_b32 v136, -8, v136
    v_and_b32 v137, -8, v137
    v_and_b32 v138, -8, v138
    v_and_b32 v139, -8, v139
    v_and_b32 v140, -8, v140
    v_and_b32 v141, -8, v141
    v_and_b32 v142, -8, v142
    v_and_b32 v143, -8, v143
    v_and_b32 v144, -8, v144
    v_and_b32 v145, -8, v145
    v_and_b32 v146, -8, v146
    v_and_b32 v147, -8, v147
    v_and_b32 v148, -8, v148
    v_and_b32 v149, -8, v149
    v_and_b32 v150, -8, v150
    v_and_b32 v151, -8, v151
    v_and_b32 v152, -8, v152
    v_and_b32 v153, -8, v153
    v_and_b32 v154, -8, v154
    v_and_b32 v155, -8, v155
    v_and_b32 v156, -8, v156
    v_and_b32 v157, -8, v157
    v_and_b32 v158, -8, v158
    v_and_b32 v159, -8, v159
    v_pk_add_f32 v[128:129], v[128:129], v[132:133]
    v_pk_add_f32 v[136:137], v[136:137], v[140:141]
    v_pk_add_f32 v[130:131], v[130:131], v[134:135]
    v_pk_add_f32 v[138:139], v[138:139], v[142:143]
    v_pk_add_f32 v[68:69], v[128:129], v[136:137]
    v_pk_add_f32 v[70:71], v[130:131], v[138:139]
    v_cvt_pk_bf16_f32 v69, v68, v69
    v_cvt_pk_bf16_f32 v71, v70, v71
    v_lshlrev_b32 v68, 16, v69
    v_and_b32 v69, 0xffff0000, v69
    v_lshlrev_b32 v70, 16, v71
    v_and_b32 v71, 0xffff0000, v71
    v_pk_add_f32 v[144:145], v[144:145], v[148:149]
    v_pk_add_f32 v[152:153], v[152:153], v[156:157]
    v_pk_add_f32 v[146:147], v[146:147], v[150:151]
    v_pk_add_f32 v[154:155], v[154:155], v[158:159]
    v_pk_add_f32 v[52:53], v[144:145], v[152:153]
    v_pk_add_f32 v[54:55], v[146:147], v[154:155]
    v_cvt_pk_bf16_f32 v53, v52, v53
    v_cvt_pk_bf16_f32 v55, v54, v55
    v_lshlrev_b32 v52, 16, v53
    v_and_b32 v53, 0xffff0000, v53
    v_lshlrev_b32 v54, 16, v55
    v_and_b32 v55, 0xffff0000, v55
    v_add_f32 v52, 1.0, v52
    v_add_f32 v53, 1.0, v53
    v_add_f32 v54, 1.0, v54
    v_add_f32 v55, 1.0, v55
    v_cvt_pk_bf16_f32 v53, v52, v53
    v_cvt_pk_bf16_f32 v55, v54, v55
    v_lshlrev_b32 v52, 16, v53
    v_and_b32 v53, 0xffff0000, v53
    v_lshlrev_b32 v54, 16, v55
    v_and_b32 v55, 0xffff0000, v55
    v_pk_mul_f32 v[16:17], v[16:17], v[52:53]
    v_pk_mul_f32 v[18:19], v[18:19], v[54:55]
    v_cvt_pk_bf16_f32 v17, v16, v17
    v_cvt_pk_bf16_f32 v19, v18, v19
    v_lshlrev_b32 v16, 16, v17
    v_and_b32 v17, 0xffff0000, v17
    v_lshlrev_b32 v18, 16, v19
    v_and_b32 v19, 0xffff0000, v19
    v_pk_add_f32 v[16:17], v[16:17], v[68:69]
    v_pk_add_f32 v[18:19], v[18:19], v[70:71]
    v_cvt_pk_bf16_f32 v32, v16, v17
    v_cvt_pk_bf16_f32 v33, v18, v19
    ds_write_b64 v9, v[32:33] offset:6144
    v_mov_b32 v14, 1
    ds_write_b32 v1, v14 offset:52
    s_branch Lh_19
Lr_18:
    s_sub_u32 s5, s5, 1
    s_cbranch_scc1 L_done
Lh_19:
    ds_read_b128 v[100:103], v1 offset:32
    ds_read_b128 v[104:107], v4 offset:768
    s_waitcnt lgkmcnt(1)
    v_min3_u32 v100, v100, v101, v102
    v_min_u32 v100, v100, v103
    v_cmp_gt_u32 vcc, 2, v100
    s_cbranch_vccnz Lr_18
    s_waitcnt lgkmcnt(0)
    v_add_u32 v104, 4, v104
    v_add_u32 v105, 4, v105
    v_add_u32 v106, 4, v106
    v_add_u32 v107, 4, v107
    v_and_or_b32 v104, v104, -8, s84
    v_and_or_b32 v105, v105, -8, s85
    v_and_or_b32 v106, v106, -8, s86
    v_and_or_b32 v107, v107, -8, s87
    s_and_b32 exec_lo, exec_lo, 0xffffffff
    s_mov_b32 exec_hi, 0
    s_cbranch_execz Lx_20
    buffer_store_dwordx4 v[104:107], v3, s[44:47], s89 offen sc1
Lx_20:
    s_mov_b64 exec, s[100:101]
    s_branch Lh_22
Lr_21:
    s_sub_u32 s5, s5, 1
    s_cbranch_scc1 L_done
Lh_22:
    ds_read_b32 v14, v1 offset:0
    s_waitcnt lgkmcnt(0)
    v_cmp_gt_u32 vcc, 14, v14
    s_cbranch_vccnz Lr_21
    s_branch L_s_q
L_s_notB:
    s_waitcnt vmcnt(0)
    v_add_u32 v118, 1, v118
    v_readfirstlane_b32 s7, v119
    v_readfirstlane_b32 s6, v118
    ds_write_b64 v1, v[118:119] offset:128
    s_lshr_b32 s66, s2, 6
    s_lshl_b32 s66, s66, 12
    s_and_b32 s69, s2, 7
    s_lshl_b32 s69, s69, 9
    s_add_u32 s69, s69, s66
    s_add_u32 s69, s69, 163840
    s_bfe_u32 s84, s6, 0x30000
    s_bfe_u32 s85, s6, 0x30003
    s_bfe_u32 s86, s6, 0x30006
    s_bfe_u32 s87, s6, 0x30009
    s_bfe_u32 s65, s2, 0x30003
    s_cmp_eq_u32 s65, 7
    s_cselect_b32 s65, 5, 11
    s_branch Lh_24
Lr_23:
    s_sub_u32 s5, s5, 1
    s_cbranch_scc1 L_done
Lh_24:
    ds_read_b32 v14, v1 offset:0
    s_waitcnt lgkmcnt(0)
    v_cmp_gt_u32 vcc, s65, v14
    s_cbranch_vccnz Lr_23
    s_lshr_b32 s65, s9, 1
    s_branch Lh_26
Lr_25:
    s_sub_u32 s5, s5, 1
    s_cbranch_scc1 L_done
Lh_26:
    ds_read_b128 v[104:107], v1 offset:32
    s_waitcnt lgkmcnt(0)
    v_min3_u32 v104, v104, v105, v106
    v_min_u32 v104, v104, v107
    v_cmp_gt_u32 vcc, s65, v104
    s_cbranch_vccnz Lr_25
L_s_q:
    s_lshr_b32 s66, s2, 6
    s_lshl_b32 s66, s66, 12
    s_add_u32 s76, s66, 163840
    s_add_u32 s77, s76, 16384
    s_add_u32 s78, s76, 32768
    s_add_u32 s79, s76, 49152
    s_cbranch_execz Lx_30
    buffer_load_dwordx4 v[128:131], v3, s[44:47], s76 offen offset:0 sc1
    buffer_load_dwordx4 v[132:135], v3, s[44:47], s76 offen offset:1024 sc1
    buffer_load_dwordx4 v[136:139], v3, s[44:47], s76 offen offset:2048 sc1
    buffer_load_dwordx4 v[140:143], v3, s[44:47], s76 offen offset:3072 sc1
    buffer_load_dwordx4 v[144:147], v3, s[44:47], s77 offen offset:0 sc1
    buffer_load_dwordx4 v[148:151], v3, s[44:47], s77 offen offset:1024 sc1
    buffer_load_dwordx4 v[152:155], v3, s[44:47], s77 offen offset:2048 sc1
    buffer_load_dwordx4 v[156:159], v3, s[44:47], s77 offen offset:3072 sc1
    buffer_load_dwordx4 v[160:163], v3, s[44:47], s78 offen offset:0 sc1
    buffer_load_dwordx4 v[164:167], v3, s[44:47], s78 offen offset:1024 sc1
    buffer_load_dwordx4 v[168:171], v3, s[44:47], s78 offen offset:2048 sc1
    buffer_load_dwordx4 v[172:175], v3, s[44:47], s78 offen offset:3072 sc1
    buffer_load_dwordx4 v[176:179], v3, s[44:47], s79 offen offset:0 sc1
    buffer_load_dwordx4 v[180:183], v3, s[44:47], s79 offen offset:1024 sc1
    buffer_load_dwordx4 v[184:187], v3, s[44:47], s79 offen offset:2048 sc1
    buffer_load_dwordx4 v[188:191], v3, s[44:47], s79 offen offset:3072 sc1
Lx_30:
    s_branch Lc_28
Lg_27:
    s_mov_b64 exec, s[16:17]
    s_cbranch_execz Ls_31
    buffer_load_dwordx4 v[128:131], v3, s[44:47], s76 offen offset:0 sc1
Ls_31:
    s_mov_b64 exec, s[18:19]
    s_cbranch_execz Ls_32
    buffer_load_dwordx4 v[132:135], v3, s[44:47], s76 offen offset:1024 sc1
Ls_32:
    s_mov_b64 exec, s[20:21]
    s_cbranch_execz Ls_33
    buffer_load_dwordx4 v[136:139], v3, s[44:47], s76 offen offset:2048 sc1
Ls_33:
    s_mov_b64 exec, s[22:23]
    s_cbranch_execz Ls_34
    buffer_load_dwordx4 v[140:143], v3, s[44:47], s76 offen offset:3072 sc1
Ls_34:
    s_mov_b64 exec, s[24:25]
    s_cbranch_execz Ls_35
    buffer_load_dwordx4 v[144:147], v3, s[44:47], s77 offen offset:0 sc1
Ls_35:
    s_mov_b64 exec, s[26:27]
    s_cbranch_execz Ls_36
    buffer_load_dwordx4 v[148:151], v3, s[44:47], s77 offen offset:1024 sc1
Ls_36:
    s_mov_b64 exec, s[28:29]
    s_cbranch_execz Ls_37
    buffer_load_dwordx4 v[152:155], v3, s[44:47], s77 offen offset:2048 sc1
Ls_37:
    s_mov_b64 exec, s[30:31]
    s_cbranch_execz Ls_38
    buffer_load_dwordx4 v[156:159], v3, s[44:47], s77 offen offset:3072 sc1
Ls_38:
    s_mov_b64 exec, s[32:33]
    s_cbranch_execz Ls_39
    buffer_load_dwordx4 v[160:163], v3, s[44:47], s78 offen offset:0 sc1
Ls_39:
    s_mov_b64 exec, s[34:35]
    s_cbranch_execz Ls_40
    buffer_load_dwordx4 v[164:167], v3, s[44:47], s78 offen offset:1024 sc1
Ls_40:
    s_mov_b64 exec, s[36:37]
    s_cbranch_execz Ls_41
    buffer_load_dwordx4 v[168:171], v3, s[44:47], s78 offen offset:2048 sc1
Ls_41:
    s_mov_b64 exec, s[38:39]
    s_cbranch_execz Ls_42
    buffer_load_dwordx4 v[172:175], v3, s[44:47], s78 offen offset:3072 sc1
Ls_42:
    s_mov_b64 exec, s[40:41]
    s_cbranch_execz Ls_43
    buffer_load_dwordx4 v[176:179], v3, s[44:47], s79 offen offset:0 sc1
Ls_43:
    s_mov_b64 exec, s[42:43]
    s_cbranch_execz Ls_44
    buffer_load_dwordx4 v[180:183], v3, s[44:47], s79 offen offset:1024 sc1
Ls_44:
    s_mov_b64 exec, s[70:71]
    s_cbranch_execz Ls_45
    buffer_load_dwordx4 v[184:187], v3, s[44:47], s79 offen offset:2048 sc1
Ls_45:
    s_mov_b64 exec, s[72:73]
    s_cbranch_execz Ls_46
    buffer_load_dwordx4 v[188:191], v3, s[44:47], s79 offen offset:3072 sc1
Ls_46:
    s_mov_b64 exec, -1
Lc_28:
    s_waitcnt vmcnt(0)
    v_xor_b32 v100, s84, v128
    v_bitop3_b32 v100, v129, s85, v100 bitop3:0xbe
    v_bitop3_b32 v100, v130, s86, v100 bitop3:0xbe
    v_bitop3_b32 v100, v131, s87, v100 bitop3:0xbe
    v_xor_b32 v101, s84, v132
    v_bitop3_b32 v101, v133, s85, v101 bitop3:0xbe
    v_bitop3_b32 v101, v134, s86, v101 bitop3:0xbe
    v_bitop3_b32 v101, v135, s87, v101 bitop3:0xbe
    v_xor_b32 v102, s84, v136
    v_bitop3_b32 v102, v137, s85, v102 bitop3:0xbe
    v_bitop3_b32 v102, v138, s86, v102 bitop3:0xbe
    v_bitop3_b32 v102, v139, s87, v102 bitop3:0xbe
    v_xor_b32 v103, s84, v140
    v_bitop3_b32 v103, v141, s85, v103 bitop3:0xbe
    v_bitop3_b32 v103, v142, s86, v103 bitop3:0xbe
    v_bitop3_b32 v103, v143, s87, v103 bitop3:0xbe
    v_or_b32_dpp v100, v100, v100 quad_perm:[1,0,3,2] row_mask:0xf bank_mask:0xf
    v_or_b32_dpp v101, v101, v101 quad_perm:[1,0,3,2] row_mask:0xf bank_mask:0xf
    v_or_b32_dpp v102, v102, v102 quad_perm:[1,0,3,2] row_mask:0xf bank_mask:0xf
    v_or_b32_dpp v103, v103, v103 quad_perm:[1,0,3,2] row_mask:0xf bank_mask:0xf
    v_or_b32_dpp v100, v100, v100 quad_perm:[2,3,0,1] row_mask:0xf bank_mask:0xf
    v_or_b32_dpp v101, v101, v101 quad_perm:[2,3,0,1] row_mask:0xf bank_mask:0xf
    v_or_b32_dpp v102, v102, v102 quad_perm:[2,3,0,1] row_mask:0xf bank_mask:0xf
    v_or_b32_dpp v103, v103, v103 quad_perm:[2,3,0,1] row_mask:0xf bank_mask:0xf
    v_and_b32 v100, 7, v100
    v_cmp_ne_u32 s[16:17], 0, v100
    v_and_b32 v101, 7, v101
    v_cmp_ne_u32 s[18:19], 0, v101
    v_and_b32 v102, 7, v102
    v_cmp_ne_u32 s[20:21], 0, v102
    v_and_b32 v103, 7, v103
    v_cmp_ne_u32 s[22:23], 0, v103
    v_xor_b32 v100, s84, v144
    v_bitop3_b32 v100, v145, s85, v100 bitop3:0xbe
    v_bitop3_b32 v100, v146, s86, v100 bitop3:0xbe
    v_bitop3_b32 v100, v147, s87, v100 bitop3:0xbe
    v_xor_b32 v101, s84, v148
    v_bitop3_b32 v101, v149, s85, v101 bitop3:0xbe
    v_bitop3_b32 v101, v150, s86, v101 bitop3:0xbe
    v_bitop3_b32 v101, v151, s87, v101 bitop3:0xbe
    v_xor_b32 v102, s84, v152
    v_bitop3_b32 v102, v153, s85, v102 bitop3:0xbe
    v_bitop3_b32 v102, v154, s86, v102 bitop3:0xbe
    v_bitop3_b32 v102, v155, s87, v102 bitop3:0xbe
    v_xor_b32 v103, s84, v156
    v_bitop3_b32 v103, v157, s85, v103 bitop3:0xbe
    v_bitop3_b32 v103, v158, s86, v103 bitop3:0xbe
    v_bitop3_b32 v103, v159, s87, v103 bitop3:0xbe
    v_or_b32_dpp v100, v100, v100 quad_perm:[1,0,3,2] row_mask:0xf bank_mask:0xf
    v_or_b32_dpp v101, v101, v101 quad_perm:[1,0,3,2] row_mask:0xf bank_mask:0xf
    v_or_b32_dpp v102, v102, v102 quad_perm:[1,0,3,2] row_mask:0xf bank_mask:0xf
    v_or_b32_dpp v103, v103, v103 quad_perm:[1,0,3,2] row_mask:0xf bank_mask:0xf
    v_or_b32_dpp v100, v100, v100 quad_perm:[2,3,0,1] row_mask:0xf bank_mask:0xf
    v_or_b32_dpp v101, v101, v101 quad_perm:[2,3,0,1] row_mask:0xf bank_mask:0xf
    v_or_b32_dpp v102, v102, v102 quad_perm:[2,3,0,1] row_mask:0xf bank_mask:0xf
    v_or_b32_dpp v103, v103, v103 quad_perm:[2,3,0,1] row_mask:0xf bank_mask:0xf
    v_and_b32 v100, 7, v100
    v_cmp_ne_u32 s[24:25], 0, v100
    v_and_b32 v101, 7, v101
    v_cmp_ne_u32 s[26:27], 0, v101
    v_and_b32 v102, 7, v102
    v_cmp_ne_u32 s[28:29], 0, v102
    v_and_b32 v103, 7, v103
    v_cmp_ne_u32 s[30:31], 0, v103
    v_xor_b32 v100, s84, v160
    v_bitop3_b32 v100, v161, s85, v100 bitop3:0xbe
    v_bitop3_b32 v100, v162, s86, v100 bitop3:0xbe
    v_bitop3_b32 v100, v163, s87, v100 bitop3:0xbe
    v_xor_b32 v101, s84, v164
    v_bitop3_b32 v101, v165, s85, v101 bitop3:0xbe
    v_bitop3_b32 v101, v166, s86, v101 bitop3:0xbe
    v_bitop3_b32 v101, v167, s87, v101 bitop3:0xbe
    v_xor_b32 v102, s84, v168
    v_bitop3_b32 v102, v169, s85, v102 bitop3:0xbe
    v_bitop3_b32 v102, v170, s86, v102 bitop3:0xbe
    v_bitop3_b32 v102, v171, s87, v102 bitop3:0xbe
    v_xor_b32 v103, s84, v172
    v_bitop3_b32 v103, v173, s85, v103 bitop3:0xbe
    v_bitop3_b32 v103, v174, s86, v103 bitop3:0xbe
    v_bitop3_b32 v103, v175, s87, v103 bitop3:0xbe
    v_or_b32_dpp v100, v100, v100 quad_perm:[1,0,3,2] row_mask:0xf bank_mask:0xf
    v_or_b32_dpp v101, v101, v101 quad_perm:[1,0,3,2] row_mask:0xf bank_mask:0xf
    v_or_b32_dpp v102, v102, v102 quad_perm:[1,0,3,2] row_mask:0xf bank_mask:0xf
    v_or_b32_dpp v103, v103, v103 quad_perm:[1,0,3,2] row_mask:0xf bank_mask:0xf
    v_or_b32_dpp v100, v100, v100 quad_perm:[2,3,0,1] row_mask:0xf bank_mask:0xf
    v_or_b32_dpp v101, v101, v101 quad_perm:[2,3,0,1] row_mask:0xf bank_mask:0xf
    v_or_b32_dpp v102, v102, v102 quad_perm:[2,3,0,1] row_mask:0xf bank_mask:0xf
    v_or_b32_dpp v103, v103, v103 quad_perm:[2,3,0,1] row_mask:0xf bank_mask:0xf
    v_and_b32 v100, 7, v100
    v_cmp_ne_u32 s[32:33], 0, v100
    v_and_b32 v101, 7, v101
    v_cmp_ne_u32 s[34:35], 0, v101
    v_and_b32 v102, 7, v102
    v_cmp_ne_u32 s[36:37], 0, v102
    v_and_b32 v103, 7, v103
    v_cmp_ne_u32 s[38:39], 0, v103
    v_xor_b32 v100, s84, v176
    v_bitop3_b32 v100, v177, s85, v100 bitop3:0xbe
    v_bitop3_b32 v100, v178, s86, v100 bitop3:0xbe
    v_bitop3_b32 v100, v179, s87, v100 bitop3:0xbe
    v_xor_b32 v101, s84, v180
    v_bitop3_b32 v101, v181, s85, v101 bitop3:0xbe
    v_bitop3_b32 v101, v182, s86, v101 bitop3:0xbe
    v_bitop3_b32 v101, v183, s87, v101 bitop3:0xbe
    v_xor_b32 v102, s84, v184
    v_bitop3_b32 v102, v185, s85, v102 bitop3:0xbe
    v_bitop3_b32 v102, v186, s86, v102 bitop3:0xbe
    v_bitop3_b32 v102, v187, s87, v102 bitop3:0xbe
    v_xor_b32 v103, s84, v188
    v_bitop3_b32 v103, v189, s85, v103 bitop3:0xbe
    v_bitop3_b32 v103, v190, s86, v103 bitop3:0xbe
    v_bitop3_b32 v103, v191, s87, v103 bitop3:0xbe
    v_or_b32_dpp v100, v100, v100 quad_perm:[1,0,3,2] row_mask:0xf bank_mask:0xf
    v_or_b32_dpp v101, v101, v101 quad_perm:[1,0,3,2] row_mask:0xf bank_mask:0xf
    v_or_b32_dpp v102, v102, v102 quad_perm:[1,0,3,2] row_mask:0xf bank_mask:0xf
    v_or_b32_dpp v103, v103, v103 quad_perm:[1,0,3,2] row_mask:0xf bank_mask:0xf
    v_or_b32_dpp v100, v100, v100 quad_perm:[2,3,0,1] row_mask:0xf bank_mask:0xf
    v_or_b32_dpp v101, v101, v101 quad_perm:[2,3,0,1] row_mask:0xf bank_mask:0xf
    v_or_b32_dpp v102, v102, v102 quad_perm:[2,3,0,1] row_mask:0xf bank_mask:0xf
    v_or_b32_dpp v103, v103, v103 quad_perm:[2,3,0,1] row_mask:0xf bank_mask:0xf
    v_and_b32 v100, 7, v100
    v_cmp_ne_u32 s[40:41], 0, v100
    v_and_b32 v101, 7, v101
    v_cmp_ne_u32 s[42:43], 0, v101
    v_and_b32 v102, 7, v102
    v_cmp_ne_u32 s[70:71], 0, v102
    v_and_b32 v103, 7, v103
    v_cmp_ne_u32 s[72:73], 0, v103
    s_mov_b64 s[12:13], s[16:17]
    s_or_b64 s[12:13], s[12:13], s[18:19]
    s_or_b64 s[12:13], s[12:13], s[20:21]
    s_or_b64 s[12:13], s[12:13], s[22:23]
    s_or_b64 s[12:13], s[12:13], s[24:25]
    s_or_b64 s[12:13], s[12:13], s[26:27]
    s_or_b64 s[12:13], s[12:13], s[28:29]
    s_or_b64 s[12:13], s[12:13], s[30:31]
    s_or_b64 s[12:13], s[12:13], s[32:33]
    s_or_b64 s[12:13], s[12:13], s[34:35]
    s_or_b64 s[12:13], s[12:13], s[36:37]
    s_or_b64 s[12:13], s[12:13], s[38:39]
    s_or_b64 s[12:13], s[12:13], s[40:41]
    s_or_b64 s[12:13], s[12:13], s[42:43]
    s_or_b64 s[12:13], s[12:13], s[70:71]
    s_or_b64 s[12:13], s[12:13], s[72:73]
    s_cmp_eq_u64 s[12:13], 0
    s_cbranch_scc1 Ld_29
    s_sub_u32 s5, s5, 16
    s_cbranch_scc0 Lg_27
    s_branch L_done
Ld_29:
    v_and_b32 v128, -8, v128
    v_and_b32 v129, -8, v129
    v_and_b32 v130, -8, v130
    v_and_b32 v131, -8, v131
    v_and_b32 v132, -8, v132
    v_and_b32 v133, -8, v133
    v_and_b32 v134, -8, v134
    v_and_b32 v135, -8, v135
    v_and_b32 v136, -8, v136
    v_and_b32 v137, -8, v137
    v_and_b32 v138, -8, v138
    v_and_b32 v139, -8, v139
    v_and_b32 v140, -8, v140
    v_and_b32 v141, -8, v141
    v_and_b32 v142, -8, v142
    v_and_b32 v143, -8, v143
    v_and_b32 v144, -8, v144
    v_and_b32 v145, -8, v145
    v_and_b32 v146, -8, v146
    v_and_b32 v147, -8, v147
    v_and_b32 v148, -8, v148
    v_and_b32 v149, -8, v149
    v_and_b32 v150, -8, v150
    v_and_b32 v151, -8, v151
    v_and_b32 v152, -8, v152
    v_and_b32 v153, -8, v153
    v_and_b32 v154, -8, v154
    v_and_b32 v155, -8, v155
    v_and_b32 v156, -8, v156
    v_and_b32 v157, -8, v157
    v_and_b32 v158, -8, v158
    v_and_b32 v159, -8, v159
    v_and_b32 v160, -8, v160
    v_and_b32 v161, -8, v161
    v_and_b32 v162, -8, v162
    v_and_b32 v163, -8, v163
    v_and_b32 v164, -8, v164
    v_and_b32 v165, -8, v165
    v_and_b32 v166, -8, v166
    v_and_b32 v167, -8, v167
    v_and_b32 v168, -8, v168
    v_and_b32 v169, -8, v169
    v_and_b32 v170, -8, v170
    v_and_b32 v171, -8, v171
    v_and_b32 v172, -8, v172
    v_and_b32 v173, -8, v173
    v_and_b32 v174, -8, v174
    v_and_b32 v175, -8, v175
    v_and_b32 v176, -8, v176
    v_and_b32 v177, -8, v177
    v_and_b32 v178, -8, v178
    v_and_b32 v179, -8, v179
    v_and_b32 v180, -8, v180
    v_and_b32 v181, -8, v181
    v_and_b32 v182, -8, v182
    v_and_b32 v183, -8, v183
    v_and_b32 v184, -8, v184
    v_and_b32 v185, -8, v185
    v_and_b32 v186, -8, v186
    v_and_b32 v187, -8, v187
    v_and_b32 v188, -8, v188
    v_and_b32 v189, -8, v189
    v_and_b32 v190, -8, v190
    v_and_b32 v191, -8, v191
    v_pk_add_f32 v[128:129], v[128:129], v[144:145]
    v_pk_add_f32 v[160:161], v[160:161], v[176:177]
    v_pk_add_f32 v[130:131], v[130:131], v[146:147]
    v_pk_add_f32 v[162:163], v[162:163], v[178:179]
    v_pk_add_f32 v[128:129], v[128:129], v[160:161]
    v_pk_add_f32 v[130:131], v[130:131], v[162:163]
    v_pk_add_f32 v[132:133], v[132:133], v[148:149]
    v_pk_add_f32 v[164:165], v[164:165], v[180:181]
    v_pk_add_f32 v[134:135], v[134:135], v[150:151]
    v_pk_add_f32 v[166:167], v[166:167], v[182:183]
    v_pk_add_f32 v[132:133], v[132:133], v[164:165]
    v_pk_add_f32 v[134:135], v[134:135], v[166:167]
    v_pk_add_f32 v[136:137], v[136:137], v[152:153]
    v_pk_add_f32 v[168:169], v[168:169], v[184:185]
    v_pk_add_f32 v[138:139], v[138:139], v[154:155]
    v_pk_add_f32 v[170:171], v[170:171], v[186:187]
    v_pk_add_f32 v[136:137], v[136:137], v[168:169]
    v_pk_add_f32 v[138:139], v[138:139], v[170:171]
    v_pk_add_f32 v[140:141], v[140:141], v[156:157]
    v_pk_add_f32 v[172:173], v[172:173], v[188:189]
    v_pk_add_f32 v[142:143], v[142:143], v[158:159]
    v_pk_add_f32 v[174:175], v[174:175], v[190:191]
    v_pk_add_f32 v[140:141], v[140:141], v[172:173]
    v_pk_add_f32 v[142:143], v[142:143], v[174:175]
    v_cvt_pk_bf16_f32 v128, v128, v129
    v_cvt_pk_bf16_f32 v129, v130, v131
    ds_write_b64 v9, v[128:129] offset:10240
    v_cvt_pk_bf16_f32 v132, v132, v133
    v_cvt_pk_bf16_f32 v133, v134, v135
    ds_write_b64 v9, v[132:133] offset:10752
    v_cvt_pk_bf16_f32 v136, v136, v137
    v_cvt_pk_bf16_f32 v137, v138, v139
    ds_write_b64 v9, v[136:137] offset:11264
    v_cvt_pk_bf16_f32 v140, v140, v141
    v_cvt_pk_bf16_f32 v141, v142, v143
    ds_write_b64 v9, v[140:141] offset:11776
    v_mov_b32 v14, 1
    ds_write_b32 v1, v14 offset:56
    s_getreg_b32 s75, hwreg(HW_REG_XCC_ID)
    s_bfe_u32 s75, s75, 0x10002
    s_cmp_eq_u32 s9, 1
    s_cbranch_scc1 L_s_sel
    s_cmp_eq_u32 s9, 2
    s_cbranch_scc1 L_s_vote
    s_branch Lh_48
Lr_47:
    s_sub_u32 s5, s5, 1
    s_cbranch_scc1 L_done
Lh_48:
    ds_read_b128 v[100:103], v1 offset:32
    ds_read_b128 v[104:107], v4 offset:1280
    s_waitcnt lgkmcnt(1)
    v_min3_u32 v100, v100, v101, v102
    v_min_u32 v100, v100, v103
    v_cmp_gt_u32 vcc, 3, v100
    s_cbranch_vccnz Lr_47
    s_waitcnt lgkmcnt(0)
    v_add_u32 v104, 4, v104
    v_add_u32 v105, 4, v105
    v_add_u32 v106, 4, v106
    v_add_u32 v107, 4, v107
    v_and_or_b32 v104, v104, -8, s84
    v_and_or_b32 v105, v105, -8, s85
    v_and_or_b32 v106, v106, -8, s86
    v_and_or_b32 v107, v107, -8, s87
    s_and_b32 exec_lo, exec_lo, 0xffffffff
    s_mov_b32 exec_hi, 0
    s_cbranch_execz Lx_49
    buffer_store_dwordx4 v[104:107], v3, s[44:47], s90 offen sc1
Lx_49:
    s_mov_b64 exec, s[100:101]
    v_mov_b32 v116, s75
    s_lshl_b32 s65, s4, 7
    s_branch L_s_selp
L_s_vote:
    s_branch Lh_51
Lr_50:
    s_sub_u32 s5, s5, 1
    s_cbranch_scc1 L_done
Lh_51:
    ds_read_b128 v[104:107], v1 offset:32
    ds_read_b128 v[100:103], v1 offset:144
    s_waitcnt lgkmcnt(1)
    v_min3_u32 v104, v104, v105, v106
    v_min_u32 v104, v104, v107
    v_cmp_gt_u32 vcc, 1, v104
    s_cbranch_vccnz Lr_50
    s_and_b32 s65, s2, 7
    s_lshr_b32 s66, s2, 7
    s_lshl1_add_u32 s65, s65, s66
    s_add_u32 s65, s65, 128
    s_lshl_b32 s65, s65, 7
    s_waitcnt lgkmcnt(0)
    v_cmp_lt_u32 vcc, v101, v100
    v_cmp_lt_u32 s[12:13], v103, v102
    s_mul_i32 s66, s75, 3
    v_cndmask_b32 v116, 0, 1, vcc
    v_cndmask_b32 v100, 0, 2, s[12:13]
    v_or_b32 v116, v116, v100
    v_xor_b32 v116, s66, v116
L_s_selp:
    s_add_u32 s65, s65, 393216
    s_mov_b64 exec, 0xff
    buffer_store_dwordx4 v[116:119], v3, s[44:47], s65 offen sc1
    s_mov_b64 exec, -1
    s_or_b32 s65, s9, s64
    s_cbranch_scc0 L_s_red
    s_cmp_lg_u32 s2, 60
    s_cbranch_scc1 L_s_sel
    s_branch Lh_53
Lr_52:
    s_sub_u32 s5, s5, 1
    s_cbranch_scc1 L_done
Lh_53:
    ds_read_b32 v14, v1 offset:0
    s_waitcnt lgkmcnt(0)
    v_cmp_gt_u32 vcc, 16, v14
    s_cbranch_vccnz Lr_52
    v_lshlrev_b32 v13, 7, v0
    v_and_b32 v100, 15, v0
    v_lshlrev_b32 v100, 7, v100
    s_mov_b32 s65, 393216
    s_mov_b32 s66, 401408
    s_mov_b32 s69, 409600
    s_branch Lh_55
Lr_54:
    s_sleep 16
    s_sub_u32 s5, s5, 16
    s_cbranch_scc1 L_done
Lh_55:
    s_cbranch_execz Lx_56
    buffer_load_dwordx4 v[128:131], v13, s[44:47], s65 offen offset:0 sc1
    buffer_load_dwordx4 v[132:135], v13, s[44:47], s66 offen offset:0 sc1
    buffer_load_dwordx4 v[136:139], v100, s[44:47], s69 offen offset:0 sc1
Lx_56:
    s_waitcnt vmcnt(2)
    v_cmp_ne_u64 s[12:13], s[6:7], v[130:131]
    s_waitcnt vmcnt(1)
    v_cmp_ne_u64 vcc, s[6:7], v[134:135]
    s_nop 0
    s_or_b64 s[12:13], s[12:13], vcc
    s_waitcnt vmcnt(0)
    v_cmp_ne_u64 vcc, s[6:7], v[138:139]
    s_nop 0
    s_or_b64 s[12:13], s[12:13], vcc
    s_cbranch_scc1 Lr_54
    v_and_b32 v100, 1, v136
    v_cmp_eq_u32 vcc, 1, v100
    v_cmp_lt_u32 s[12:13], 1, v136
    s_bcnt1_i32_b32 s66, vcc_hi
    s_bcnt1_i32_b32 s69, s13
    s_cmp_gt_u32 s66, 16
    s_cselect_b32 s65, 1, 0
    s_cselect_b32 s12, 23, 9
    s_cmp_gt_u32 s69, s12
    s_cselect_b32 s12, 2, 0
    s_or_b32 s65, s65, s12
    v_cmp_ne_u32 s[16:17], 0, v128
    v_cmp_ne_u32 s[18:19], 0, v132
    v_mov_b32 v117, s65
    s_nop 1
    v_writelane_b32 v116, s16, 0
    v_writelane_b32 v116, s17, 1
    v_writelane_b32 v116, s18, 2
    v_writelane_b32 v116, s19, 3
    s_mov_b32 s65, 413696
    s_mov_b64 exec, 0xff
    buffer_store_dwordx4 v[116:119], v3, s[44:47], s65 offen sc1
    s_mov_b64 exec, -1
    s_branch L_s_sel
L_s_red:
    s_mov_b32 s15, 1
    s_branch Lh_58
Lr_57:
    s_sub_u32 s5, s5, 1
    s_cbranch_scc1 L_done
Lh_58:
    ds_read_b32 v14, v1 offset:0
    s_waitcnt lgkmcnt(0)
    v_cmp_gt_u32 vcc, 22, v14
    s_cbranch_vccnz Lr_57
    s_lshl_b32 s60, s4, 4
    buffer_load_dwordx2 v[98:99], v6, s[52:55], s60 offen
    s_lshl_b32 s65, s4, 5
    s_add_u32 s65, s65, 65536
    s_add_u32 s76, s65, 8192
    s_add_u32 s77, s65, 32768
    s_add_u32 s78, s65, 57344
    s_add_u32 s79, s65, 81920
    s_add_u32 s80, s65, 12288
    s_add_u32 s81, s65, 36864
    s_add_u32 s82, s65, 61440
    s_add_u32 s83, s65, 86016
    s_cbranch_execz Lx_62
    buffer_load_dwordx4 v[128:131], v12, s[44:47], s76 offen offset:0 sc1
    buffer_load_dwordx4 v[132:135], v12, s[44:47], s77 offen offset:0 sc1
    buffer_load_dwordx4 v[136:139], v12, s[44:47], s78 offen offset:0 sc1
    buffer_load_dwordx4 v[140:143], v12, s[44:47], s79 offen offset:0 sc1
    buffer_load_dwordx4 v[144:147], v12, s[44:47], s80 offen offset:0 sc1
    buffer_load_dwordx4 v[148:151], v12, s[44:47], s81 offen offset:0 sc1
    buffer_load_dwordx4 v[152:155], v12, s[44:47], s82 offen offset:0 sc1
    buffer_load_dwordx4 v[156:159], v12, s[44:47], s83 offen offset:0 sc1
Lx_62:
    s_branch Lc_60
Lg_59:
    s_mov_b64 exec, s[16:17]
    s_cbranch_execz Ls_63
    buffer_load_dwordx4 v[128:131], v12, s[44:47], s76 offen offset:0 sc1
Ls_63:
    s_mov_b64 exec, s[18:19]
    s_cbranch_execz Ls_64
    buffer_load_dwordx4 v[132:135], v12, s[44:47], s77 offen offset:0 sc1
Ls_64:
    s_mov_b64 exec, s[20:21]
    s_cbranch_execz Ls_65
    buffer_load_dwordx4 v[136:139], v12, s[44:47], s78 offen offset:0 sc1
Ls_65:
    s_mov_b64 exec, s[22:23]
    s_cbranch_execz Ls_66
    buffer_load_dwordx4 v[140:143], v12, s[44:47], s79 offen offset:0 sc1
Ls_66:
    s_mov_b64 exec, s[24:25]
    s_cbranch_execz Ls_67
    buffer_load_dwordx4 v[144:147], v12, s[44:47], s80 offen offset:0 sc1
Ls_67:
    s_mov_b64 exec, s[26:27]
    s_cbranch_execz Ls_68
    buffer_load_dwordx4 v[148:151], v12, s[44:47], s81 offen offset:0 sc1
Ls_68:
    s_mov_b64 exec, s[28:29]
    s_cbranch_execz Ls_69
    buffer_load_dwordx4 v[152:155], v12, s[44:47], s82 offen offset:0 sc1
Ls_69:
    s_mov_b64 exec, s[30:31]
    s_cbranch_execz Ls_70
    buffer_load_dwordx4 v[156:159], v12, s[44:47], s83 offen offset:0 sc1
Ls_70:
    s_mov_b64 exec, -1
Lc_60:
    s_waitcnt vmcnt(0)
    v_xor_b32 v100, s84, v128
    v_bitop3_b32 v100, v129, s85, v100 bitop3:0xbe
    v_bitop3_b32 v100, v130, s86, v100 bitop3:0xbe
    v_bitop3_b32 v100, v131, s87, v100 bitop3:0xbe
    v_xor_b32 v101, s84, v132
    v_bitop3_b32 v101, v133, s85, v101 bitop3:0xbe
    v_bitop3_b32 v101, v134, s86, v101 bitop3:0xbe
    v_bitop3_b32 v101, v135, s87, v101 bitop3:0xbe
    v_xor_b32 v102, s84, v136
    v_bitop3_b32 v102, v137, s85, v102 bitop3:0xbe
    v_bitop3_b32 v102, v138, s86, v102 bitop3:0xbe
    v_bitop3_b32 v102, v139, s87, v102 bitop3:0xbe
    v_xor_b32 v103, s84, v140
    v_bitop3_b32 v103, v141, s85, v103 bitop3:0xbe
    v_bitop3_b32 v103, v142, s86, v103 bitop3:0xbe
    v_bitop3_b32 v103, v143, s87, v103 bitop3:0xbe
    v_or_b32_dpp v100, v100, v100 quad_perm:[1,0,3,2] row_mask:0xf bank_mask:0xf
    v_or_b32_dpp v101, v101, v101 quad_perm:[1,0,3,2] row_mask:0xf bank_mask:0xf
    v_or_b32_dpp v102, v102, v102 quad_perm:[1,0,3,2] row_mask:0xf bank_mask:0xf
    v_or_b32_dpp v103, v103, v103 quad_perm:[1,0,3,2] row_mask:0xf bank_mask:0xf
    v_or_b32_dpp v100, v100, v100 quad_perm:[2,3,0,1] row_mask:0xf bank_mask:0xf
    v_or_b32_dpp v101, v101, v101 quad_perm:[2,3,0,1] row_mask:0xf bank_mask:0xf
    v_or_b32_dpp v102, v102, v102 quad_perm:[2,3,0,1] row_mask:0xf bank_mask:0xf
    v_or_b32_dpp v103, v103, v103 quad_perm:[2,3,0,1] row_mask:0xf bank_mask:0xf
    v_and_b32 v100, 7, v100
    v_cmp_ne_u32 s[16:17], 0, v100
    v_and_b32 v101, 7, v101
    v_cmp_ne_u32 s[18:19], 0, v101
    v_and_b32 v102, 7, v102
    v_cmp_ne_u32 s[20:21], 0, v102
    v_and_b32 v103, 7, v103
    v_cmp_ne_u32 s[22:23], 0, v103
    v_xor_b32 v100, s84, v144
    v_bitop3_b32 v100, v145, s85, v100 bitop3:0xbe
    v_bitop3_b32 v100, v146, s86, v100 bitop3:0xbe
    v_bitop3_b32 v100, v147, s87, v100 bitop3:0xbe
    v_xor_b32 v101, s84, v148
    v_bitop3_b32 v101, v149, s85, v101 bitop3:0xbe
    v_bitop3_b32 v101, v150, s86, v101 bitop3:0xbe
    v_bitop3_b32 v101, v151, s87, v101 bitop3:0xbe
    v_xor_b32 v102, s84, v152
    v_bitop3_b32 v102, v153, s85, v102 bitop3:0xbe
    v_bitop3_b32 v102, v154, s86, v102 bitop3:0xbe
    v_bitop3_b32 v102, v155, s87, v102 bitop3:0xbe
    v_xor_b32 v103, s84, v156
    v_bitop3_b32 v103, v157, s85, v103 bitop3:0xbe
    v_bitop3_b32 v103, v158, s86, v103 bitop3:0xbe
    v_bitop3_b32 v103, v159, s87, v103 bitop3:0xbe
    v_or_b32_dpp v100, v100, v100 quad_perm:[1,0,3,2] row_mask:0xf bank_mask:0xf
    v_or_b32_dpp v101, v101, v101 quad_perm:[1,0,3,2] row_mask:0xf bank_mask:0xf
    v_or_b32_dpp v102, v102, v102 quad_perm:[1,0,3,2] row_mask:0xf bank_mask:0xf
    v_or_b32_dpp v103, v103, v103 quad_perm:[1,0,3,2] row_mask:0xf bank_mask:0xf
    v_or_b32_dpp v100, v100, v100 quad_perm:[2,3,0,1] row_mask:0xf bank_mask:0xf
    v_or_b32_dpp v101, v101, v101 quad_perm:[2,3,0,1] row_mask:0xf bank_mask:0xf
    v_or_b32_dpp v102, v102, v102 quad_perm:[2,3,0,1] row_mask:0xf bank_mask:0xf
    v_or_b32_dpp v103, v103, v103 quad_perm:[2,3,0,1] row_mask:0xf bank_mask:0xf
    v_and_b32 v100, 7, v100
    v_cmp_ne_u32 s[24:25], 0, v100
    v_and_b32 v101, 7, v101
    v_cmp_ne_u32 s[26:27], 0, v101
    v_and_b32 v102, 7, v102
    v_cmp_ne_u32 s[28:29], 0, v102
    v_and_b32 v103, 7, v103
    v_cmp_ne_u32 s[30:31], 0, v103
    s_mov_b64 s[12:13], s[16:17]
    s_or_b64 s[12:13], s[12:13], s[18:19]
    s_or_b64 s[12:13], s[12:13], s[20:21]
    s_or_b64 s[12:13], s[12:13], s[22:23]
    s_or_b64 s[12:13], s[12:13], s[24:25]
    s_or_b64 s[12:13], s[12:13], s[26:27]
    s_or_b64 s[12:13], s[12:13], s[28:29]
    s_or_b64 s[12:13], s[12:13], s[30:31]
    s_cmp_eq_u64 s[12:13], 0
    s_cbranch_scc1 Ld_61
    s_sub_u32 s5, s5, 16
    s_cbranch_scc0 Lg_59
    s_branch L_done
Ld_61:
    v_and_b32 v128, -8, v128
    v_and_b32 v129, -8, v129
    v_and_b32 v130, -8, v130
    v_and_b32 v131, -8, v131
    v_and_b32 v132, -8, v132
    v_and_b32 v133, -8, v133
    v_and_b32 v134, -8, v134
    v_and_b32 v135, -8, v135
    v_and_b32 v136, -8, v136
    v_and_b32 v137, -8, v137
    v_and_b32 v138, -8, v138
    v_and_b32 v139, -8, v139
    v_and_b32 v140, -8, v140
    v_and_b32 v141, -8, v141
    v_and_b32 v142, -8, v142
    v_and_b32 v143, -8, v143
    v_and_b32 v144, -8, v144
    v_and_b32 v145, -8, v145
    v_and_b32 v146, -8, v146
    v_and_b32 v147, -8, v147
    v_and_b32 v148, -8, v148
    v_and_b32 v149, -8, v149
    v_and_b32 v150, -8, v150
    v_and_b32 v151, -8, v151
    v_and_b32 v152, -8, v152
    v_and_b32 v153, -8, v153
    v_and_b32 v154, -8, v154
    v_and_b32 v155, -8, v155
    v_and_b32 v156, -8, v156
    v_and_b32 v157, -8, v157
    v_and_b32 v158, -8, v158
    v_and_b32 v159, -8, v159
    v_pk_add_f32 v[128:129], v[128:129], v[132:133]
    v_pk_add_f32 v[136:137], v[136:137], v[140:141]
    v_pk_add_f32 v[130:131], v[130:131], v[134:135]
    v_pk_add_f32 v[138:139], v[138:139], v[142:143]
    v_pk_add_f32 v[16:17], v[128:129], v[136:137]
    v_pk_add_f32 v[18:19], v[130:131], v[138:139]
    v_pk_add_f32 v[144:145], v[144:145], v[148:149]
    v_pk_add_f32 v[152:153], v[152:153], v[156:157]
    v_pk_add_f32 v[146:147], v[146:147], v[150:151]
    v_pk_add_f32 v[154:155], v[154:155], v[158:159]
    v_pk_add_f32 v[20:21], v[144:145], v[152:153]
    v_pk_add_f32 v[22:23], v[146:147], v[154:155]
    s_add_u32 s76, s65, 16384
    s_add_u32 s77, s65, 40960
    s_add_u32 s78, s65, 65536
    s_add_u32 s79, s65, 90112
    s_add_u32 s80, s65, 20480
    s_add_u32 s81, s65, 45056
    s_add_u32 s82, s65, 69632
    s_add_u32 s83, s65, 94208
    s_cbranch_execz Lx_74
    buffer_load_dwordx4 v[128:131], v12, s[44:47], s76 offen offset:0 sc1
    buffer_load_dwordx4 v[132:135], v12, s[44:47], s77 offen offset:0 sc1
    buffer_load_dwordx4 v[136:139], v12, s[44:47], s78 offen offset:0 sc1
    buffer_load_dwordx4 v[140:143], v12, s[44:47], s79 offen offset:0 sc1
    buffer_load_dwordx4 v[144:147], v12, s[44:47], s80 offen offset:0 sc1
    buffer_load_dwordx4 v[148:151], v12, s[44:47], s81 offen offset:0 sc1
    buffer_load_dwordx4 v[152:155], v12, s[44:47], s82 offen offset:0 sc1
    buffer_load_dwordx4 v[156:159], v12, s[44:47], s83 offen offset:0 sc1
Lx_74:
    s_branch Lc_72
Lg_71:
    s_mov_b64 exec, s[16:17]
    s_cbranch_execz Ls_75
    buffer_load_dwordx4 v[128:131], v12, s[44:47], s76 offen offset:0 sc1
Ls_75:
    s_mov_b64 exec, s[18:19]
    s_cbranch_execz Ls_76
    buffer_load_dwordx4 v[132:135], v12, s[44:47], s77 offen offset:0 sc1
Ls_76:
    s_mov_b64 exec, s[20:21]
    s_cbranch_execz Ls_77
    buffer_load_dwordx4 v[136:139], v12, s[44:47], s78 offen offset:0 sc1
Ls_77:
    s_mov_b64 exec, s[22:23]
    s_cbranch_execz Ls_78
    buffer_load_dwordx4 v[140:143], v12, s[44:47], s79 offen offset:0 sc1
Ls_78:
    s_mov_b64 exec, s[24:25]
    s_cbranch_execz Ls_79
    buffer_load_dwordx4 v[144:147], v12, s[44:47], s80 offen offset:0 sc1
Ls_79:
    s_mov_b64 exec, s[26:27]
    s_cbranch_execz Ls_80
    buffer_load_dwordx4 v[148:151], v12, s[44:47], s81 offen offset:0 sc1
Ls_80:
    s_mov_b64 exec, s[28:29]
    s_cbranch_execz Ls_81
    buffer_load_dwordx4 v[152:155], v12, s[44:47], s82 offen offset:0 sc1
Ls_81:
    s_mov_b64 exec, s[30:31]
    s_cbranch_execz Ls_82
    buffer_load_dwordx4 v[156:159], v12, s[44:47], s83 offen offset:0 sc1
Ls_82:
    s_mov_b64 exec, -1
Lc_72:
    s_waitcnt vmcnt(0)
    v_xor_b32 v100, s84, v128
    v_bitop3_b32 v100, v129, s85, v100 bitop3:0xbe
    v_bitop3_b32 v100, v130, s86, v100 bitop3:0xbe
    v_bitop3_b32 v100, v131, s87, v100 bitop3:0xbe
    v_xor_b32 v101, s84, v132
    v_bitop3_b32 v101, v133, s85, v101 bitop3:0xbe
    v_bitop3_b32 v101, v134, s86, v101 bitop3:0xbe
    v_bitop3_b32 v101, v135, s87, v101 bitop3:0xbe
    v_xor_b32 v102, s84, v136
    v_bitop3_b32 v102, v137, s85, v102 bitop3:0xbe
    v_bitop3_b32 v102, v138, s86, v102 bitop3:0xbe
    v_bitop3_b32 v102, v139, s87, v102 bitop3:0xbe
    v_xor_b32 v103, s84, v140
    v_bitop3_b32 v103, v141, s85, v103 bitop3:0xbe
    v_bitop3_b32 v103, v142, s86, v103 bitop3:0xbe
    v_bitop3_b32 v103, v143, s87, v103 bitop3:0xbe
    v_or_b32_dpp v100, v100, v100 quad_perm:[1,0,3,2] row_mask:0xf bank_mask:0xf
    v_or_b32_dpp v101, v101, v101 quad_perm:[1,0,3,2] row_mask:0xf bank_mask:0xf
    v_or_b32_dpp v102, v102, v102 quad_perm:[1,0,3,2] row_mask:0xf bank_mask:0xf
    v_or_b32_dpp v103, v103, v103 quad_perm:[1,0,3,2] row_mask:0xf bank_mask:0xf
    v_or_b32_dpp v100, v100, v100 quad_perm:[2,3,0,1] row_mask:0xf bank_mask:0xf
    v_or_b32_dpp v101, v101, v101 quad_perm:[2,3,0,1] row_mask:0xf bank_mask:0xf
    v_or_b32_dpp v102, v102, v102 quad_perm:[2,3,0,1] row_mask:0xf bank_mask:0xf
    v_or_b32_dpp v103, v103, v103 quad_perm:[2,3,0,1] row_mask:0xf bank_mask:0xf
    v_and_b32 v100, 7, v100
    v_cmp_ne_u32 s[16:17], 0, v100
    v_and_b32 v101, 7, v101
    v_cmp_ne_u32 s[18:19], 0, v101
    v_and_b32 v102, 7, v102
    v_cmp_ne_u32 s[20:21], 0, v102
    v_and_b32 v103, 7, v103
    v_cmp_ne_u32 s[22:23], 0, v103
    v_xor_b32 v100, s84, v144
    v_bitop3_b32 v100, v145, s85, v100 bitop3:0xbe
    v_bitop3_b32 v100, v146, s86, v100 bitop3:0xbe
    v_bitop3_b32 v100, v147, s87, v100 bitop3:0xbe
    v_xor_b32 v101, s84, v148
    v_bitop3_b32 v101, v149, s85, v101 bitop3:0xbe
    v_bitop3_b32 v101, v150, s86, v101 bitop3:0xbe
    v_bitop3_b32 v101, v151, s87, v101 bitop3:0xbe
    v_xor_b32 v102, s84, v152
    v_bitop3_b32 v102, v153, s85, v102 bitop3:0xbe
    v_bitop3_b32 v102, v154, s86, v102 bitop3:0xbe
    v_bitop3_b32 v102, v155, s87, v102 bitop3:0xbe
    v_xor_b32 v103, s84, v156
    v_bitop3_b32 v103, v157, s85, v103 bitop3:0xbe
    v_bitop3_b32 v103, v158, s86, v103 bitop3:0xbe
    v_bitop3_b32 v103, v159, s87, v103 bitop3:0xbe
    v_or_b32_dpp v100, v100, v100 quad_perm:[1,0,3,2] row_mask:0xf bank_mask:0xf
    v_or_b32_dpp v101, v101, v101 quad_perm:[1,0,3,2] row_mask:0xf bank_mask:0xf
    v_or_b32_dpp v102, v102, v102 quad_perm:[1,0,3,2] row_mask:0xf bank_mask:0xf
    v_or_b32_dpp v103, v103, v103 quad_perm:[1,0,3,2] row_mask:0xf bank_mask:0xf
    v_or_b32_dpp v100, v100, v100 quad_perm:[2,3,0,1] row_mask:0xf bank_mask:0xf
    v_or_b32_dpp v101, v101, v101 quad_perm:[2,3,0,1] row_mask:0xf bank_mask:0xf
    v_or_b32_dpp v102, v102, v102 quad_perm:[2,3,0,1] row_mask:0xf bank_mask:0xf
    v_or_b32_dpp v103, v103, v103 quad_perm:[2,3,0,1] row_mask:0xf bank_mask:0xf
    v_and_b32 v100, 7, v100
    v_cmp_ne_u32 s[24:25], 0, v100
    v_and_b32 v101, 7, v101
    v_cmp_ne_u32 s[26:27], 0, v101
    v_and_b32 v102, 7, v102
    v_cmp_ne_u32 s[28:29], 0, v102
    v_and_b32 v103, 7, v103
    v_cmp_ne_u32 s[30:31], 0, v103
    s_mov_b64 s[12:13], s[16:17]
    s_or_b64 s[12:13], s[12:13], s[18:19]
    s_or_b64 s[12:13], s[12:13], s[20:21]
    s_or_b64 s[12:13], s[12:13], s[22:23]
    s_or_b64 s[12:13], s[12:13], s[24:25]
    s_or_b64 s[12:13], s[12:13], s[26:27]
    s_or_b64 s[12:13], s[12:13], s[28:29]
    s_or_b64 s[12:13], s[12:13], s[30:31]
    s_cmp_eq_u64 s[12:13], 0
    s_cbranch_scc1 Ld_73
    s_sub_u32 s5, s5, 16
    s_cbranch_scc0 Lg_71
    s_branch L_done
Ld_73:
    v_and_b32 v128, -8, v128
    v_and_b32 v129, -8, v129
    v_and_b32 v130, -8, v130
    v_and_b32 v131, -8, v131
    v_and_b32 v132, -8, v132
    v_and_b32 v133, -8, v133
    v_and_b32 v134, -8, v134
    v_and_b32 v135, -8, v135
    v_and_b32 v136, -8, v136
    v_and_b32 v137, -8, v137
    v_and_b32 v138, -8, v138
    v_and_b32 v139, -8, v139
    v_and_b32 v140, -8, v140
    v_and_b32 v141, -8, v141
    v_and_b32 v142, -8, v142
    v_and_b32 v143, -8, v143
    v_and_b32 v144, -8, v144
    v_and_b32 v145, -8, v145
    v_and_b32 v146, -8, v146
    v_and_b32 v147, -8, v147
    v_and_b32 v148, -8, v148
    v_and_b32 v149, -8, v149
    v_and_b32 v150, -8, v150
    v_and_b32 v151, -8, v151
    v_and_b32 v152, -8, v152
    v_and_b32 v153, -8, v153
    v_and_b32 v154, -8, v154
    v_and_b32 v155, -8, v155
    v_and_b32 v156, -8, v156
    v_and_b32 v157, -8, v157
    v_and_b32 v158, -8, v158
    v_and_b32 v159, -8, v159
    v_pk_add_f32 v[128:129], v[128:129], v[132:133]
    v_pk_add_f32 v[136:137], v[136:137], v[140:141]
    v_pk_add_f32 v[130:131], v[130:131], v[134:135]
    v_pk_add_f32 v[138:139], v[138:139], v[142:143]
    v_pk_add_f32 v[24:25], v[128:129], v[136:137]
    v_pk_add_f32 v[26:27], v[130:131], v[138:139]
    v_pk_add_f32 v[144:145], v[144:145], v[148:149]
    v_pk_add_f32 v[152:153], v[152:153], v[156:157]
    v_pk_add_f32 v[146:147], v[146:147], v[150:151]
    v_pk_add_f32 v[154:155], v[154:155], v[158:159]
    v_pk_add_f32 v[28:29], v[144:145], v[152:153]
    v_pk_add_f32 v[30:31], v[146:147], v[154:155]
    s_lshl_b32 s61, s4, 5
    s_add_u32 s65, s61, 266240
    s_add_u32 s66, s65, 4096
    s_add_u32 s61, s61, 524288
    v_cvt_pk_bf16_f32 v116, v20, v21
    v_cvt_pk_bf16_f32 v117, v22, v23
    s_mov_b64 exec, 0xff
    buffer_store_dwordx4 v[116:119], v5, s[44:47], s65 offen sc1
    s_nop 1
    v_cvt_pk_bf16_f32 v116, v24, v25
    v_cvt_pk_bf16_f32 v117, v26, v27
    buffer_store_dwordx4 v[116:119], v5, s[44:47], s66 offen sc1
    s_mov_b64 exec, -1
    v_cvt_pk_bf16_f32 v17, v16, v17
    v_cvt_pk_bf16_f32 v19, v18, v19
    v_lshlrev_b32 v16, 16, v17
    v_and_b32 v17, 0xffff0000, v17
    v_lshlrev_b32 v18, 16, v19
    v_and_b32 v19, 0xffff0000, v19
    v_cvt_pk_bf16_f32 v29, v28, v29
    v_cvt_pk_bf16_f32 v31, v30, v31
    v_lshlrev_b32 v28, 16, v29
    v_and_b32 v29, 0xffff0000, v29
    v_lshlrev_b32 v30, 16, v31
    v_and_b32 v31, 0xffff0000, v31
    v_lshlrev_b32 v24, 16, v98
    v_and_b32 v25, 0xffff0000, v98
    v_lshlrev_b32 v26, 16, v99
    v_and_b32 v27, 0xffff0000, v99
    v_add_u32 v13, v12, v1
    ds_write_b128 v13, v[16:19] offset:4096
    ds_write_b128 v13, v[24:27] offset:4224
    ds_write_b128 v13, v[28:31] offset:4352
L_s_sel:
    s_bfe_u32 s65, s2, 0x30003
    s_cmp_eq_u32 s65, 7
    s_cselect_b32 s65, 18, 28
    s_cmp_eq_u32 s9, 0
    s_cselect_b32 s65, 34, s65
    s_cmp_eq_u32 s9, 2
    s_cselect_b32 s65, 24, s65
    s_branch Lh_84
Lr_83:
    s_sub_u32 s5, s5, 1
    s_cbranch_scc1 L_done
Lh_84:
    ds_read_b32 v14, v1 offset:0
    s_waitcnt lgkmcnt(0)
    v_cmp_gt_u32 vcc, s65, v14
    s_cbranch_vccnz Lr_83
    s_lshr_b32 s65, s2, 6
    v_mov_b32 v13, s65
    v_bfe_u32 v100, v0, 3, 2
    v_and_b32 v101, 7, v0
    v_lshlrev_b32 v101, 2, v101
    v_cmp_lt_u32 vcc, 31, v0
    s_nop 1
    v_cndmask_b32 v13, v13, v100, vcc
    v_cndmask_b32 v101, v0, v101, vcc
    v_lshlrev_b32 v13, 4, v13
    s_mov_b32 s65, 413696
    s_branch Lh_86
Lr_85:
    s_sleep 64
    s_sub_u32 s5, s5, 16
    s_cbranch_scc1 L_done
Lh_86:
    s_cbranch_execz Lx_87
    buffer_load_dwordx4 v[128:131], v13, s[44:47], s65 offen offset:0 sc1
Lx_87:
    s_waitcnt vmcnt(0)
    v_cmp_ne_u64 s[12:13], s[6:7], v[130:131]
    s_nop 0
    s_cmp_lg_u64 s[12:13], 0
    s_cbranch_scc1 Lr_85
    v_readfirstlane_b32 s65, v129
    v_bfe_u32 v100, v128, v101, 1
    v_lshrrev_b32 v101, 5, v0
    v_xor_b32 v101, 1, v101
    v_bfe_u32 v101, v129, v101, 1
    v_xor_b32 v100, v100, v101
    v_lshlrev_b32 v100, 13, v100
    s_lshr_b32 s66, s65, 1
    s_xor_b32 s66, s66, s75
    s_lshl_b32 s66, s66, 13
    s_and_b32 s65, s65, 1
    s_xor_b32 s75, s75, s65
    s_lshl_b32 s75, s75, 13
    v_mov_b32 v102, s75
    v_mov_b32 v103, s66
    ds_write_b32 v7, v100 offset:3840
    ds_write_b64 v1, v[102:103] offset:136
    v_mov_b32 v14, 1
    ds_write_b32 v1, v14 offset:8
    s_cmp_eq_u32 s9, 2
    s_cbranch_scc1 L_s_end
    s_cmp_lg_u32 s9, 0
    s_cbranch_scc1 L_s_cs
    s_branch L_s_noe
L_s_cs:
    s_mov_b32 s66, 266240
    s_mov_b32 s69, 270336
    s_branch Lh_89
Lr_88:
    s_sub_u32 s5, s5, 1
    s_cbranch_scc1 L_done
Lh_89:
    ds_read_b32 v14, v1 offset:68
    s_waitcnt lgkmcnt(0)
    v_cmp_gt_u32 vcc, 1, v14
    s_cbranch_vccnz Lr_88
    s_branch Lh_91
Lr_90:
    s_sub_u32 s5, s5, 16
    s_cbranch_scc1 L_done
Lh_91:
    s_cbranch_execz Lx_92
    buffer_load_dwordx4 v[128:131], v3, s[44:47], s66 offen offset:0 sc1
    buffer_load_dwordx4 v[132:135], v3, s[44:47], s66 offen offset:1024 sc1
    buffer_load_dwordx4 v[136:139], v3, s[44:47], s66 offen offset:2048 sc1
    buffer_load_dwordx4 v[140:143], v3, s[44:47], s66 offen offset:3072 sc1
    buffer_load_dwordx4 v[144:147], v3, s[44:47], s69 offen offset:0 sc1
    buffer_load_dwordx4 v[148:151], v3, s[44:47], s69 offen offset:1024 sc1
    buffer_load_dwordx4 v[152:155], v3, s[44:47], s69 offen offset:2048 sc1
    buffer_load_dwordx4 v[156:159], v3, s[44:47], s69 offen offset:3072 sc1
Lx_92:
    s_waitcnt vmcnt(7)
    v_cmp_ne_u64 s[12:13], s[6:7], v[130:131]
    s_waitcnt vmcnt(6)
    v_cmp_ne_u64 vcc, s[6:7], v[134:135]
    s_nop 0
    s_or_b64 s[12:13], s[12:13], vcc
    s_waitcnt vmcnt(5)
    v_cmp_ne_u64 vcc, s[6:7], v[138:139]
    s_nop 0
    s_or_b64 s[12:13], s[12:13], vcc
    s_waitcnt vmcnt(4)
    v_cmp_ne_u64 vcc, s[6:7], v[142:143]
    s_nop 0
    s_or_b64 s[12:13], s[12:13], vcc
    s_waitcnt vmcnt(3)
    v_cmp_ne_u64 vcc, s[6:7], v[146:147]
    s_nop 0
    s_or_b64 s[12:13], s[12:13], vcc
    s_waitcnt vmcnt(2)
    v_cmp_ne_u64 vcc, s[6:7], v[150:151]
    s_nop 0
    s_or_b64 s[12:13], s[12:13], vcc
    s_waitcnt vmcnt(1)
    v_cmp_ne_u64 vcc, s[6:7], v[154:155]
    s_nop 0
    s_or_b64 s[12:13], s[12:13], vcc
    s_waitcnt vmcnt(0)
    v_cmp_ne_u64 vcc, s[6:7], v[158:159]
    s_nop 0
    s_or_b64 s[12:13], s[12:13], vcc
    s_cbranch_scc1 Lr_90
    ds_write_b64 v9, v[128:129] offset:4096
    ds_write_b64 v9, v[144:145] offset:6144
    ds_write_b64 v9, v[132:133] offset:4608
    ds_write_b64 v9, v[148:149] offset:6656
    ds_write_b64 v9, v[136:137] offset:5120
    ds_write_b64 v9, v[152:153] offset:7168
    ds_write_b64 v9, v[140:141] offset:5632
    ds_write_b64 v9, v[156:157] offset:7680
    v_mov_b32 v14, 1
    ds_write_b32 v1, v14 offset:64
    s_branch L_s_end
L_s_noe:
    s_lshr_b32 s66, s2, 6
    s_lshl_b32 s66, s66, 14
    s_add_u32 s66, s66, s75
    s_bfe_u32 s69, s4, 0x30002
    s_lshl_b32 s69, s69, 4
    s_add_u32 s66, s66, s69
    s_add_u32 s66, s66, 458752
    v_lshlrev_b32 v13, 7, v0
    s_mov_b64 s[100:101], 0
    s_mov_b64 exec, 0
    s_branch L_s_tb
L_s_tb_ret:
    s_waitcnt lgkmcnt(0)
    s_mov_b64 s[100:101], -1
    s_mov_b64 exec, -1
L_s_tb:
    s_branch Lh_94
Lr_93:
    s_sub_u32 s5, s5, 1
    s_cbranch_scc1 L_done
Lh_94:
    ds_read_b32 v14, v1 offset:68
    s_waitcnt lgkmcnt(0)
    v_cmp_gt_u32 vcc, 1, v14
    s_cbranch_vccnz Lr_93
    s_branch L_s_mlh
L_s_mlr:
    s_sub_u32 s5, s5, 16
    s_cbranch_scc1 L_done
    s_mov_b64 exec, vcc
L_s_mlh:
    s_cbranch_execz Lx_95
    buffer_load_dwordx4 v[120:123], v13, s[44:47], s66 offen sc1
Lx_95:
    s_waitcnt vmcnt(0)
    v_cmp_ne_u64 vcc, s[6:7], v[122:123]
    s_cbranch_vccnz L_s_mlr
    s_mov_b64 exec, s[100:101]
    v_mov_b32 v14, 1
    ds_write_b32 v1, v14 offset:76
    v_mov_b32 v92, v120
    s_nop 1
    v_max_f32_dpp v92, v92, v92 quad_perm:[1,0,3,2] row_mask:0xf bank_mask:0xf
    s_nop 1
    v_max_f32_dpp v92, v92, v92 quad_perm:[2,3,0,1] row_mask:0xf bank_mask:0xf
    s_nop 1
    v_max_f32_dpp v92, v92, v92 row_half_mirror row_mask:0xf bank_mask:0xf
    s_nop 1
    v_max_f32_dpp v92, v92, v92 row_mirror row_mask:0xf bank_mask:0xf
    v_mov_b32 v93, v92
    s_nop 1
    v_permlane16_swap_b32 v92, v93
    v_max_f32 v92, v92, v93
    v_mov_b32 v93, v92
    s_nop 1
    v_permlane32_swap_b32 v92, v93
    v_max_f32 v92, v92, v93
    v_sub_f32 v92, v120, v92
    v_exp_f32 v92, v92
    s_nop 0
    v_mul_f32 v96, v92, v121
    s_nop 1
    v_add_f32_dpp v96, v96, v96 quad_perm:[1,0,3,2] row_mask:0xf bank_mask:0xf
    s_nop 1
    v_add_f32_dpp v96, v96, v96 quad_perm:[2,3,0,1] row_mask:0xf bank_mask:0xf
    s_nop 1
    v_add_f32_dpp v96, v96, v96 row_half_mirror row_mask:0xf bank_mask:0xf
    s_nop 1
    v_add_f32_dpp v96, v96, v96 row_mirror row_mask:0xf bank_mask:0xf
    v_mov_b32 v94, v96
    s_nop 1
    v_permlane16_swap_b32 v96, v94
    v_add_f32 v96, v96, v94
    v_mov_b32 v94, v96
    s_nop 1
    v_permlane32_swap_b32 v96, v94
    v_add_f32 v96, v96, v94
    v_rcp_f32 v96, v96
    v_mov_b32 v14, 2
    v_mul_f32 v92, v92, v96
    ds_write_b32 v7, v92 offset:3584
    ds_write_b32 v1, v14 offset:76
    s_cbranch_execz L_s_tb_ret
L_s_end:
    s_endpgm
.p2align 6
L_ld_go:
    s_barrier
    s_mov_b32 s60, 2
    s_mov_b32 s58, 32768
    s_mov_b32 s48, s22
    s_mov_b32 s49, s23
    s_mov_b32 s50, 0x800000
    s_mov_b32 s51, 0x20000
    v_mul_u32_u24 v4, 8192, v2
    v_add_u32 v4, v4, v3
    s_mul_i32 s52, s64, 2097152
    s_add_u32 s52, s52, s66
    s_mov_b32 s53, 64512
    s_mov_b32 s54, 68608
    s_mov_b32 s55, 2
    s_call_b64 s[56:57], L_tile32
    s_branch L_ld_B2
L_tile32:
    s_add_u32 s63, s61, 9
    s_cmp_gt_u32 s63, s60
    s_cbranch_scc0 Lslow_97
Lfree_96:
    s_add_u32 m0, s58, 0
    s_nop 0
    buffer_load_dwordx4 v4, s[48:51], s52 offen offset:0 nt lds
    s_add_u32 s52, s52, s53
    buffer_load_dwordx4 v4, s[48:51], s52 offen offset:1024 nt lds
    s_add_u32 s52, s52, s53
    buffer_load_dwordx4 v4, s[48:51], s52 offen offset:2048 nt lds
    s_add_u32 s52, s52, s53
    buffer_load_dwordx4 v4, s[48:51], s52 offen offset:3072 nt lds
    s_add_u32 s52, s52, s54
    s_waitcnt vmcnt(28)
    s_add_u32 m0, s58, 4096
    s_nop 0
    buffer_load_dwordx4 v4, s[48:51], s52 offen offset:0 nt lds
    s_add_u32 s52, s52, s53
    buffer_load_dwordx4 v4, s[48:51], s52 offen offset:1024 nt lds
    s_add_u32 s52, s52, s53
    buffer_load_dwordx4 v4, s[48:51], s52 offen offset:2048 nt lds
    s_add_u32 s52, s52, s53
    buffer_load_dwordx4 v4, s[48:51], s52 offen offset:3072 nt lds
    s_add_u32 s52, s52, s54
    s_waitcnt vmcnt(28)
    s_add_u32 m0, s58, 8192
    s_nop 0
    buffer_load_dwordx4 v4, s[48:51], s52 offen offset:0 nt lds
    s_add_u32 s52, s52, s53
    buffer_load_dwordx4 v4, s[48:51], s52 offen offset:1024 nt lds
    s_add_u32 s52, s52, s53
    buffer_load_dwordx4 v4, s[48:51], s52 offen offset:2048 nt lds
    s_add_u32 s52, s52, s53
    buffer_load_dwordx4 v4, s[48:51], s52 offen offset:3072 nt lds
    s_add_u32 s52, s52, s54
    s_waitcnt vmcnt(28)
    s_sub_i32 s63, s60, 1
    s_max_i32 s62, s62, s63
    v_mov_b32 v12, s62
    ds_write_b32 v1, v12 offset:0
    s_add_u32 m0, s58, 12288
    s_nop 0
    buffer_load_dwordx4 v4, s[48:51], s52 offen offset:0 nt lds
    s_add_u32 s52, s52, s53
    buffer_load_dwordx4 v4, s[48:51], s52 offen offset:1024 nt lds
    s_add_u32 s52, s52, s53
    buffer_load_dwordx4 v4, s[48:51], s52 offen offset:2048 nt lds
    s_add_u32 s52, s52, s53
    buffer_load_dwordx4 v4, s[48:51], s52 offen offset:3072 nt lds
    s_add_u32 s52, s52, s54
    s_waitcnt vmcnt(28)
    s_add_u32 s60, s60, 1
    s_add_u32 s58, s58, 16384
    s_cmp_eq_u32 s58, 147456
    s_cselect_b32 s58, 0, s58
    s_sub_u32 s55, s55, 1
    s_cmp_lg_u32 s55, 0
    s_cbranch_scc1 L_tile32
    s_setpc_b64 s[56:57]
L_ld_B2:
    s_add_u32 s66, s66, 128
    s_mov_b32 s48, s22
    s_mov_b32 s49, s23
    s_mov_b32 s50, 0x800000
    s_mov_b32 s51, 0x20000
    v_mul_u32_u24 v4, 8192, v2
    v_add_u32 v4, v4, v3
    s_mul_i32 s52, s64, 2097152
    s_add_u32 s52, s52, s66
    s_mov_b32 s53, 64512
    s_mov_b32 s54, 68608
    s_mov_b32 s55, 2
    s_call_b64 s[56:57], L_tile32
    s_add_u32 s66, s66, 3968
    s_mov_b32 s48, s36
    s_mov_b32 s49, s37
    s_mov_b32 s50, 0xc00000
    s_mov_b32 s51, 0x20000
    v_mul_u32_u24 v4, 12288, v2
    v_add_u32 v4, v4, v3
    s_mul_i32 s52, s64, 3145728
    s_add_u32 s52, s52, s66
    s_mov_b32 s53, 97280
    s_mov_b32 s54, 101376
    s_mov_b32 s55, 2
    s_call_b64 s[56:57], L_tile32
    s_add_u32 s66, s66, 128
    s_mov_b32 s48, s36
    s_mov_b32 s49, s37
    s_mov_b32 s50, 0xc00000
    s_mov_b32 s51, 0x20000
    v_mul_u32_u24 v4, 12288, v2
    v_add_u32 v4, v4, v3
    s_mul_i32 s52, s64, 3145728
    s_add_u32 s52, s52, s66
    s_mov_b32 s53, 97280
    s_mov_b32 s54, 101376
    s_mov_b32 s55, 2
    s_call_b64 s[56:57], L_tile32
    s_mov_b32 s48, s24
    s_mov_b32 s49, s25
    s_mov_b32 s50, 0x800000
    s_mov_b32 s51, 0x20000
    v_lshlrev_b32 v4, 4, v0
    s_lshl_b32 s52, s4, 16
    s_add_u32 s52, s52, 0
    s_mov_b32 s53, 0
    s_mov_b32 s54, 4096
    s_mov_b32 s55, 4
    s_call_b64 s[56:57], L_tile32
    s_branch L_ld_kv
.p2align 6
L_ld_A:
    s_barrier
    s_mov_b32 s60, 1
    s_movk_i32 s58, 16384
    s_mov_b32 s55, 3
    s_call_b64 s[56:57], L_tile16
    s_branch L_ld_A2
L_tile16:
    s_add_u32 s63, s61, 9
    s_cmp_gt_u32 s63, s60
    s_cbranch_scc0 Lslow_99
Lfree_98:
    s_add_u32 m0, s58, 0
    s_nop 0
    buffer_load_dwordx4 v4, s[48:51], s52 offen offset:0 nt lds
    s_add_u32 s52, s52, s53
    buffer_load_dwordx4 v4, s[48:51], s52 offen offset:1024 nt lds
    s_add_u32 s52, s52, s53
    buffer_load_dwordx4 v4, s[48:51], s52 offen offset:2048 nt lds
    s_add_u32 s52, s52, s53
    buffer_load_dwordx4 v4, s[48:51], s52 offen offset:3072 nt lds
    s_add_u32 s52, s52, s54
    s_waitcnt vmcnt(16)
    s_add_u32 m0, s58, 4096
    s_nop 0
    buffer_load_dwordx4 v4, s[48:51], s52 offen offset:0 nt lds
    s_add_u32 s52, s52, s53
    buffer_load_dwordx4 v4, s[48:51], s52 offen offset:1024 nt lds
    s_add_u32 s52, s52, s53
    buffer_load_dwordx4 v4, s[48:51], s52 offen offset:2048 nt lds
    s_add_u32 s52, s52, s53
    buffer_load_dwordx4 v4, s[48:51], s52 offen offset:3072 nt lds
    s_add_u32 s52, s52, s54
    s_waitcnt vmcnt(16)
    s_add_u32 m0, s58, 8192
    s_nop 0
    buffer_load_dwordx4 v4, s[48:51], s52 offen offset:0 nt lds
    s_add_u32 s52, s52, s53
    buffer_load_dwordx4 v4, s[48:51], s52 offen offset:1024 nt lds
    s_add_u32 s52, s52, s53
    buffer_load_dwordx4 v4, s[48:51], s52 offen offset:2048 nt lds
    s_add_u32 s52, s52, s53
    buffer_load_dwordx4 v4, s[48:51], s52 offen offset:3072 nt lds
    s_add_u32 s52, s52, s54
    s_waitcnt vmcnt(16)
    s_add_u32 m0, s58, 12288
    s_nop 0
    buffer_load_dwordx4 v4, s[48:51], s52 offen offset:0 nt lds
    s_add_u32 s52, s52, s53
    buffer_load_dwordx4 v4, s[48:51], s52 offen offset:1024 nt lds
    s_add_u32 s52, s52, s53
    buffer_load_dwordx4 v4, s[48:51], s52 offen offset:2048 nt lds
    s_add_u32 s52, s52, s53
    buffer_load_dwordx4 v4, s[48:51], s52 offen offset:3072 nt lds
    s_add_u32 s52, s52, s54
    s_waitcnt vmcnt(16)
    s_sub_i32 s63, s60, 0
    s_max_i32 s62, s62, s63
    v_mov_b32 v12, s62
    ds_write_b32 v1, v12 offset:0
    s_add_u32 s60, s60, 1
    s_add_u32 s58, s58, 16384
    s_cmp_eq_u32 s58, 147456
    s_cselect_b32 s58, 0, s58
    s_sub_u32 s55, s55, 1
    s_cmp_lg_u32 s55, 0
    s_cbranch_scc1 L_tile16
    s_setpc_b64 s[56:57]
L_ld_A2:
    s_mov_b32 s48, s30
    s_mov_b32 s49, s31
    s_mov_b32 s50, 0x700000
    s_mov_b32 s51, 0x20000
    s_bfe_u32 s83, s2, 0x30003
    s_cmp_eq_u32 s83, 7
    s_cselect_b32 s83, 4, 4
    s_lshl_b32 s52, s4, 6
    s_mov_b32 s55, s83
    s_call_b64 s[56:57], L_tile16
    s_mov_b32 s84, s52
L_ld_kv:
    s_mov_b32 s48, s18
    s_mov_b32 s49, s19
    s_mov_b32 s50, 0x4000000
    s_mov_b32 s51, 0x20000
    s_mov_b32 s52, s20
    s_mov_b32 s53, s21
    s_mov_b32 s54, 0x4000000
    s_mov_b32 s55, 0x20000
    v_lshrrev_b32 v2, 4, v0
    v_and_b32 v3, 15, v0
    v_lshlrev_b32 v5, 8, v2
    v_add_u32 v6, 0, v2
    v_xor_b32 v6, v6, v3
    v_lshl_add_u32 v16, v6, 4, v5
    v_add_u32 v6, 4, v2
    v_xor_b32 v6, v6, v3
    v_lshl_add_u32 v17, v6, 4, v5
    v_add_u32 v6, 8, v2
    v_xor_b32 v6, v6, v3
    v_lshl_add_u32 v18, v6, 4, v5
    v_add_u32 v6, 12, v2
    v_xor_b32 v6, v6, v3
    v_lshl_add_u32 v19, v6, 4, v5
    v_add_u32 v6, 0, v2
    v_lshlrev_b32 v6, 1, v6
    v_xor_b32 v6, v6, v3
    v_lshl_add_u32 v20, v6, 4, v5
    v_add_u32 v6, 4, v2
    v_lshlrev_b32 v6, 1, v6
    v_xor_b32 v6, v6, v3
    v_lshl_add_u32 v21, v6, 4, v5
    s_lshr_b32 s70, s2, 6
    s_lshl_b32 s67, s70, 24
    s_lshr_b32 s74, s2, 3
    s_add_u32 s74, s74, s2
    s_and_b32 s74, s74, 1
    s_mul_i32 s70, s70, 34816
    s_add_u32 s70, s70, 655360
    s_add_u32 s70, s42, s70
    s_addc_u32 s71, s43, 0
    s_and_b32 s65, s2, 63
    s_lshr_b32 s81, s2, 6
    s_mul_i32 s81, s81, 256
    s_mov_b32 s66, 0
    s_mov_b32 s72, s65
    s_bfe_u32 s76, s2, 0x30003
    s_lshl_b32 s77, s9, 3
    s_add_u32 s76, s76, s77
    s_cmp_eq_u32 s76, 15
    s_cselect_b32 s76, 8, 13
    s_sub_u32 s77, s76, 1
    s_bfe_u32 s78, s2, 0x10006
    s_lshl_b32 s78, s78, 2
    s_add_u32 s78, s78, 568
    s_mov_b32 s91, 0
    s_mov_b32 s79, 0
    s_mov_b32 s80, 0
    s_mov_b32 s73, 0
    s_movk_i32 s86, 4096
    s_movk_i32 s87, 4096
    s_mov_b32 s85, 0
    s_mul_i32 s82, s74, 4352
L_ld_unit:
    s_add_u32 s63, s61, 8
    s_cmp_gt_u32 s63, s60
    s_cbranch_scc0 Lslow_101
Lfree_100:
    s_add_u32 s72, s72, s81
    s_mov_b32 s68, s67
    s_bfe_u32 s69, s72, 0x30000
    s_lshl_b32 s69, s69, 14
    s_add_u32 s68, s68, s69
    s_bfe_u32 s69, s72, 0x30003
    s_lshl_b32 s69, s69, 19
    s_add_u32 s68, s68, s69
    s_bfe_u32 s69, s72, 0x20006
    s_lshl_b32 s69, s69, 17
    s_add_u32 s68, s68, s69
    s_bfe_u32 s69, s72, 0x20008
    s_lshl_b32 s69, s69, 22
    s_add_u32 s68, s68, s69
    s_mov_b32 s69, s68
    s_add_u32 m0, s58, 0
    s_nop 0
    buffer_load_dwordx4 v16, s[48:51], s69 offen offset:0 nt lds
    buffer_load_dwordx4 v17, s[48:51], s69 offen offset:1024 nt lds
    buffer_load_dwordx4 v18, s[48:51], s69 offen offset:2048 nt lds
    buffer_load_dwordx4 v19, s[48:51], s69 offen offset:3072 nt lds
    s_waitcnt vmcnt(28)
    s_add_u32 m0, s58, 4096
    s_add_u32 s69, s69, 4096
    buffer_load_dwordx4 v16, s[48:51], s69 offen offset:0 nt lds
    buffer_load_dwordx4 v17, s[48:51], s69 offen offset:1024 nt lds
    buffer_load_dwordx4 v18, s[48:51], s69 offen offset:2048 nt lds
    buffer_load_dwordx4 v19, s[48:51], s69 offen offset:3072 nt lds
    s_waitcnt vmcnt(28)
    s_add_u32 m0, s58, 8192
    s_add_u32 s69, s69, s86
    buffer_load_dwordx4 v16, s[48:51], s69 offen offset:0 nt lds
    buffer_load_dwordx4 v17, s[48:51], s69 offen offset:1024 nt lds
    buffer_load_dwordx4 v18, s[48:51], s69 offen offset:2048 nt lds
    buffer_load_dwordx4 v19, s[48:51], s69 offen offset:3072 nt lds
    s_waitcnt vmcnt(28)
    s_sub_i32 s63, s60, 1
    s_max_i32 s62, s62, s63
    v_mov_b32 v12, s62
    ds_write_b32 v1, v12 offset:0
    s_cmp_lt_u32 s66, s77
    s_cbranch_scc1 L_ld_notick
    s_cmp_lg_u32 s79, 0
    s_cbranch_scc1 L_ld_notick
    s_mov_b32 s73, 1
    s_atomic_add s73, s[70:71], s82 glc
L_ld_notick:
    s_add_u32 m0, s58, 12288
    s_add_u32 s69, s69, 4096
    buffer_load_dwordx4 v16, s[48:51], s69 offen offset:0 nt lds
    buffer_load_dwordx4 v17, s[48:51], s69 offen offset:1024 nt lds
    buffer_load_dwordx4 v18, s[48:51], s69 offen offset:2048 nt lds
    buffer_load_dwordx4 v19, s[48:51], s69 offen offset:3072 nt lds
    s_waitcnt vmcnt(28)
    s_add_u32 s60, s60, 1
    s_add_u32 s58, s58, 16384
    s_cmp_eq_u32 s58, 147456
    s_cselect_b32 s58, 0, s58
    s_cmp_eq_u32 s66, 0
    s_cbranch_scc1 L_ld_vdone
L_ld_v:
    s_mov_b32 s69, s80
    s_add_u32 m0, s58, 0
    s_nop 0
    buffer_load_dwordx4 v20, s[52:55], s69 offen offset:0 nt lds
    buffer_load_dwordx4 v21, s[52:55], s69 offen offset:1024 nt lds
    buffer_load_dwordx4 v20, s[52:55], s69 offen offset:2048 nt lds
    buffer_load_dwordx4 v21, s[52:55], s69 offen offset:3072 nt lds
    s_waitcnt vmcnt(28)
    s_add_u32 m0, s58, 4096
    s_add_u32 s69, s69, 4096
    buffer_load_dwordx4 v20, s[52:55], s69 offen offset:0 nt lds
    buffer_load_dwordx4 v21, s[52:55], s69 offen offset:1024 nt lds
    buffer_load_dwordx4 v20, s[52:55], s69 offen offset:2048 nt lds
    buffer_load_dwordx4 v21, s[52:55], s69 offen offset:3072 nt lds
    s_waitcnt vmcnt(28)
    s_add_u32 m0, s58, 8192
    s_add_u32 s69, s69, s87
    buffer_load_dwordx4 v20, s[52:55], s69 offen offset:0 nt lds
    buffer_load_dwordx4 v21, s[52:55], s69 offen offset:1024 nt lds
    buffer_load_dwordx4 v20, s[52:55], s69 offen offset:2048 nt lds
    buffer_load_dwordx4 v21, s[52:55], s69 offen offset:3072 nt lds
    s_waitcnt vmcnt(28)
    s_sub_i32 s63, s60, 1
    s_max_i32 s62, s62, s63
    v_mov_b32 v12, s62
    ds_write_b32 v1, v12 offset:0
    s_add_u32 m0, s58, 12288
    s_add_u32 s69, s69, 4096
    buffer_load_dwordx4 v20, s[52:55], s69 offen offset:0 nt lds
    buffer_load_dwordx4 v21, s[52:55], s69 offen offset:1024 nt lds
    buffer_load_dwordx4 v20, s[52:55], s69 offen offset:2048 nt lds
    buffer_load_dwordx4 v21, s[52:55], s69 offen offset:3072 nt lds
    s_waitcnt vmcnt(28)
    s_add_u32 s60, s60, 1
    s_add_u32 s58, s58, 16384
    s_cmp_eq_u32 s58, 147456
    s_cselect_b32 s58, 0, s58
    s_cmp_lg_u32 s79, 0
    s_cbranch_scc1 L_ld_kvend
L_ld_vdone:
    s_mov_b32 s80, s68
    s_mov_b32 s87, s86
    s_add_u32 s66, s66, 1
    s_lshl_b32 s72, s66, 6
    s_add_u32 s72, s72, s65
    s_cmp_lt_u32 s66, s76
    s_cbranch_scc1 L_ld_unit
L_ld_tick:
    s_waitcnt lgkmcnt(0)
    s_mul_i32 s69, s73, 2
    s_add_u32 s69, s69, s74
    s_lshr_b32 s72, s69, 2
    s_lshl_b32 s72, s72, 6
    s_and_b32 s75, s69, 3
    s_add_u32 s72, s72, s75
    s_add_u32 s72, s72, s78
    s_add_u32 s75, s69, 812
    s_cmp_lt_u32 s69, 20
    s_cselect_b32 s72, s72, s75
    s_cmp_lt_u32 s73, 106
    s_cbranch_scc1 L_ld_unit
    s_add_u32 s69, s60, 1
    v_mov_b32 v13, s69
    ds_write_b32 v1, v13 offset:4
    s_mov_b32 s79, 1
    s_add_u32 s63, s61, 9
    s_cmp_gt_u32 s63, s60
    s_cbranch_scc0 Lslow_103
Lfree_102:
    s_branch L_ld_v
L_ld_kvend:
    s_cmp_eq_u32 s9, 2
    s_cbranch_scc1 L_ld_fin
    s_cmp_eq_u32 s9, 1
    s_cbranch_scc1 L_ld_down
    s_branch L_ld_fin
L_ld_down:
    s_add_u32 s63, s61, 1
    s_cmp_gt_u32 s63, s60
    s_cbranch_scc0 Lslow_105
Lfree_104:
    s_mov_b32 s48, s32
    s_mov_b32 s49, s33
    s_mov_b32 s50, 0x700000
    s_mov_b32 s51, 0x20000
    v_lshlrev_b32 v4, 4, v0
    s_lshl_b32 s52, s4, 16
    s_add_u32 s52, s52, 0
    s_mov_b32 s53, 0
    s_mov_b32 s54, 4096
    s_mov_b32 s55, 4
    s_call_b64 s[56:57], L_tile32
L_ld_fin:
    s_waitcnt vmcnt(32)
    s_sub_i32 s63, s60, 2
    s_max_i32 s62, s62, s63
    v_mov_b32 v12, s62
    ds_write_b32 v1, v12 offset:0
    s_waitcnt vmcnt(16)
    s_sub_i32 s63, s60, 1
    s_max_i32 s62, s62, s63
    v_mov_b32 v12, s62
    ds_write_b32 v1, v12 offset:0
    s_waitcnt vmcnt(0)
    s_sub_i32 s63, s60, 0
    s_max_i32 s62, s62, s63
    v_mov_b32 v12, s62
    ds_write_b32 v1, v12 offset:0
    s_endpgm
Lslow_97:
    ds_read_b128 v[8:11], v1 offset:16
    s_waitcnt lgkmcnt(0)
    v_min3_u32 v8, v8, v9, v10
    v_min_u32 v8, v8, v11
    s_nop 0
    v_readfirstlane_b32 s61, v8
    s_nop 0
    s_add_u32 s63, s61, 9
    s_cmp_gt_u32 s63, s60
    s_cbranch_scc1 Lfree_96
    s_waitcnt vmcnt(32)
    s_sub_i32 s63, s60, 2
    s_max_i32 s62, s62, s63
    v_mov_b32 v12, s62
    ds_write_b32 v1, v12 offset:0
    s_waitcnt vmcnt(16)
    s_sub_i32 s63, s60, 1
    s_max_i32 s62, s62, s63
    v_mov_b32 v12, s62
    ds_write_b32 v1, v12 offset:0
    ds_read_b128 v[8:11], v1 offset:16
    s_waitcnt lgkmcnt(0)
    v_min3_u32 v8, v8, v9, v10
    v_min_u32 v8, v8, v11
    s_nop 0
    v_readfirstlane_b32 s61, v8
    s_nop 0
    s_add_u32 s63, s61, 9
    s_cmp_gt_u32 s63, s60
    s_cbranch_scc1 Lfree_96
    s_waitcnt vmcnt(0)
    s_sub_i32 s63, s60, 0
    s_max_i32 s62, s62, s63
    v_mov_b32 v12, s62
    ds_write_b32 v1, v12 offset:0
Lsp_106:
    ds_read_b128 v[8:11], v1 offset:16
    s_waitcnt lgkmcnt(0)
    v_min3_u32 v8, v8, v9, v10
    v_min_u32 v8, v8, v11
    s_nop 0
    v_readfirstlane_b32 s61, v8
    s_nop 0
    s_add_u32 s63, s61, 9
    s_cmp_gt_u32 s63, s60
    s_cbranch_scc1 Lfree_96
    s_sub_u32 s5, s5, 1
    s_cbranch_scc0 Lsp_106
    s_branch L_done
Lslow_99:
    ds_read_b128 v[8:11], v1 offset:16
    s_waitcnt lgkmcnt(0)
    v_min3_u32 v8, v8, v9, v10
    v_min_u32 v8, v8, v11
    s_nop 0
    v_readfirstlane_b32 s61, v8
    s_nop 0
    s_add_u32 s63, s61, 9
    s_cmp_gt_u32 s63, s60
    s_cbranch_scc1 Lfree_98
    s_waitcnt vmcnt(32)
    s_sub_i32 s63, s60, 2
    s_max_i32 s62, s62, s63
    v_mov_b32 v12, s62
    ds_write_b32 v1, v12 offset:0
    s_waitcnt vmcnt(16)
    s_sub_i32 s63, s60, 1
    s_max_i32 s62, s62, s63
    v_mov_b32 v12, s62
    ds_write_b32 v1, v12 offset:0
    ds_read_b128 v[8:11], v1 offset:16
    s_waitcnt lgkmcnt(0)
    v_min3_u32 v8, v8, v9, v10
    v_min_u32 v8, v8, v11
    s_nop 0
    v_readfirstlane_b32 s61, v8
    s_nop 0
    s_add_u32 s63, s61, 9
    s_cmp_gt_u32 s63, s60
    s_cbranch_scc1 Lfree_98
    s_waitcnt vmcnt(0)
    s_sub_i32 s63, s60, 0
    s_max_i32 s62, s62, s63
    v_mov_b32 v12, s62
    ds_write_b32 v1, v12 offset:0
Lsp_107:
    ds_read_b128 v[8:11], v1 offset:16
    s_waitcnt lgkmcnt(0)
    v_min3_u32 v8, v8, v9, v10
    v_min_u32 v8, v8, v11
    s_nop 0
    v_readfirstlane_b32 s61, v8
    s_nop 0
    s_add_u32 s63, s61, 9
    s_cmp_gt_u32 s63, s60
    s_cbranch_scc1 Lfree_98
    s_sub_u32 s5, s5, 1
    s_cbranch_scc0 Lsp_107
    s_branch L_done
Lslow_101:
    ds_read_b128 v[8:11], v1 offset:16
    s_waitcnt lgkmcnt(0)
    v_min3_u32 v8, v8, v9, v10
    v_min_u32 v8, v8, v11
    s_nop 0
    v_readfirstlane_b32 s61, v8
    s_nop 0
    s_add_u32 s63, s61, 8
    s_cmp_gt_u32 s63, s60
    s_cbranch_scc1 Lfree_100
    s_waitcnt vmcnt(32)
    s_sub_i32 s63, s60, 2
    s_max_i32 s62, s62, s63
    v_mov_b32 v12, s62
    ds_write_b32 v1, v12 offset:0
    s_waitcnt vmcnt(16)
    s_sub_i32 s63, s60, 1
    s_max_i32 s62, s62, s63
    v_mov_b32 v12, s62
    ds_write_b32 v1, v12 offset:0
    ds_read_b128 v[8:11], v1 offset:16
    s_waitcnt lgkmcnt(0)
    v_min3_u32 v8, v8, v9, v10
    v_min_u32 v8, v8, v11
    s_nop 0
    v_readfirstlane_b32 s61, v8
    s_nop 0
    s_add_u32 s63, s61, 8
    s_cmp_gt_u32 s63, s60
    s_cbranch_scc1 Lfree_100
    s_waitcnt vmcnt(0)
    s_sub_i32 s63, s60, 0
    s_max_i32 s62, s62, s63
    v_mov_b32 v12, s62
    ds_write_b32 v1, v12 offset:0
Lsp_108:
    ds_read_b128 v[8:11], v1 offset:16
    s_waitcnt lgkmcnt(0)
    v_min3_u32 v8, v8, v9, v10
    v_min_u32 v8, v8, v11
    s_nop 0
    v_readfirstlane_b32 s61, v8
    s_nop 0
    s_add_u32 s63, s61, 8
    s_cmp_gt_u32 s63, s60
    s_cbranch_scc1 Lfree_100
    s_sub_u32 s5, s5, 1
    s_cbranch_scc0 Lsp_108
    s_branch L_done
Lslow_103:
    ds_read_b128 v[8:11], v1 offset:16
    s_waitcnt lgkmcnt(0)
    v_min3_u32 v8, v8, v9, v10
    v_min_u32 v8, v8, v11
    s_nop 0
    v_readfirstlane_b32 s61, v8
    s_nop 0
    s_add_u32 s63, s61, 9
    s_cmp_gt_u32 s63, s60
    s_cbranch_scc1 Lfree_102
    s_waitcnt vmcnt(32)
    s_sub_i32 s63, s60, 2
    s_max_i32 s62, s62, s63
    v_mov_b32 v12, s62
    ds_write_b32 v1, v12 offset:0
    s_waitcnt vmcnt(16)
    s_sub_i32 s63, s60, 1
    s_max_i32 s62, s62, s63
    v_mov_b32 v12, s62
    ds_write_b32 v1, v12 offset:0
    ds_read_b128 v[8:11], v1 offset:16
    s_waitcnt lgkmcnt(0)
    v_min3_u32 v8, v8, v9, v10
    v_min_u32 v8, v8, v11
    s_nop 0
    v_readfirstlane_b32 s61, v8
    s_nop 0
    s_add_u32 s63, s61, 9
    s_cmp_gt_u32 s63, s60
    s_cbranch_scc1 Lfree_102
    s_waitcnt vmcnt(0)
    s_sub_i32 s63, s60, 0
    s_max_i32 s62, s62, s63
    v_mov_b32 v12, s62
    ds_write_b32 v1, v12 offset:0
Lsp_109:
    ds_read_b128 v[8:11], v1 offset:16
    s_waitcnt lgkmcnt(0)
    v_min3_u32 v8, v8, v9, v10
    v_min_u32 v8, v8, v11
    s_nop 0
    v_readfirstlane_b32 s61, v8
    s_nop 0
    s_add_u32 s63, s61, 9
    s_cmp_gt_u32 s63, s60
    s_cbranch_scc1 Lfree_102
    s_sub_u32 s5, s5, 1
    s_cbranch_scc0 Lsp_109
    s_branch L_done
Lslow_105:
    ds_read_b128 v[8:11], v1 offset:16
    s_waitcnt lgkmcnt(0)
    v_min3_u32 v8, v8, v9, v10
    v_min_u32 v8, v8, v11
    s_nop 0
    v_readfirstlane_b32 s61, v8
    s_nop 0
    s_add_u32 s63, s61, 1
    s_cmp_gt_u32 s63, s60
    s_cbranch_scc1 Lfree_104
    s_waitcnt vmcnt(32)
    s_sub_i32 s63, s60, 2
    s_max_i32 s62, s62, s63
    v_mov_b32 v12, s62
    ds_write_b32 v1, v12 offset:0
    s_waitcnt vmcnt(16)
    s_sub_i32 s63, s60, 1
    s_max_i32 s62, s62, s63
    v_mov_b32 v12, s62
    ds_write_b32 v1, v12 offset:0
    ds_read_b128 v[8:11], v1 offset:16
    s_waitcnt lgkmcnt(0)
    v_min3_u32 v8, v8, v9, v10
    v_min_u32 v8, v8, v11
    s_nop 0
    v_readfirstlane_b32 s61, v8
    s_nop 0
    s_add_u32 s63, s61, 1
    s_cmp_gt_u32 s63, s60
    s_cbranch_scc1 Lfree_104
    s_waitcnt vmcnt(0)
    s_sub_i32 s63, s60, 0
    s_max_i32 s62, s62, s63
    v_mov_b32 v12, s62
    ds_write_b32 v1, v12 offset:0
Lsp_110:
    ds_read_b128 v[8:11], v1 offset:16
    s_waitcnt lgkmcnt(0)
    v_min3_u32 v8, v8, v9, v10
    v_min_u32 v8, v8, v11
    s_nop 0
    v_readfirstlane_b32 s61, v8
    s_nop 0
    s_add_u32 s63, s61, 1
    s_cmp_gt_u32 s63, s60
    s_cbranch_scc1 Lfree_104
    s_sub_u32 s5, s5, 1
    s_cbranch_scc0 Lsp_110
    s_branch L_done
L_consumer:
    s_sub_u32 s8, s3, 1
    s_lshl_b32 s12, s8, 2
    v_add_u32 v2, s12, v1
    v_lshrrev_b32 v7, 4, v0
    v_and_b32 v8, 15, v0
    v_lshrrev_b32 v3, 2, v0
    v_lshlrev_b32 v3, 6, v3
    v_and_b32 v9, 3, v0
    v_lshl_add_u32 v3, v9, 3, v3
    v_and_b32 v9, 1, v7
    v_lshlrev_b32 v9, 5, v9
    v_xor_b32 v3, v3, v9
    s_lshl_b32 s12, s8, 9
    v_lshlrev_b32 v4, 3, v7
    v_add3_u32 v4, v4, s12, v1
    v_lshlrev_b32 v5, 3, v0
    v_add_u32 v5, s12, v5
    v_lshl_add_u32 v6, v8, 4, v2
    s_mov_b32 s58, 0
    s_mov_b32 s60, 0
    s_mov_b32 s61, 0
    s_mov_b32 s70, 0x05040100
    s_mov_b32 s71, 0x07060302
    s_mov_b32 s10, 0x00ff00ff
    s_mov_b32 s11, 0x00ff00ff
    s_mov_b32 s72, 0x3db504f3
    s_mov_b32 s73, 0x3db504f3
    s_mov_b32 s74, 0x3fb8aa3b
    s_cmp_eq_u32 s9, 0
    s_cbranch_scc1 L_c_B
    s_cmp_ge_u32 s61, 1
    s_cbranch_scc1 Lf_111
Lw_112:
    ds_read_b32 v14, v1 offset:0
    s_waitcnt lgkmcnt(0)
    v_readfirstlane_b32 s61, v14
    s_nop 0
    s_cmp_ge_u32 s61, 1
    s_cbranch_scc1 Ld_113
    s_cbranch_execz Ld_113
    s_sub_u32 s5, s5, 1
    s_cbranch_scc0 Lw_112
    s_branch L_done
Ld_113:
Lf_111:
    s_mov_b32 s79, s61
    s_mov_b64 s[100:101], 0
    s_mov_b64 exec, 0
    s_branch L_c_q
L_c_dryA_ret:
    s_waitcnt lgkmcnt(0)
    s_mov_b64 s[100:101], -1
    s_mov_b64 exec, -1
    s_mov_b32 s58, 0
    s_mov_b32 s60, 0
    s_mov_b32 s61, s79
    s_cmp_lg_u32 s9, 2
    s_cbranch_scc1 L_c_noprobe
    s_and_b32 s12, s2, 7
    s_lshr_b32 s13, s2, 7
    s_lshl1_add_u32 s12, s12, s13
    s_mul_i32 s12, s12, 16896
    s_and_b32 s13, s8, 1
    s_lshl_b32 s13, s13, 13
    s_add_u32 s12, s12, s13
    s_lshr_b32 s13, s8, 1
    s_mul_i32 s13, s13, 1048576
    s_add_u32 s12, s12, s13
    s_add_u32 s12, s12, 1048576
    s_mov_b32 s66, -1
    s_mov_b32 s67, 9
L_c_probe:
    s_memtime s[84:85]
    s_waitcnt lgkmcnt(0)
    s_buffer_load_dword s13, s[44:47], s12 glc
    s_waitcnt lgkmcnt(0)
    s_memtime s[86:87]
    s_waitcnt lgkmcnt(0)
    s_sub_u32 s13, s86, s84
    s_min_u32 s66, s66, s13
    s_sub_u32 s67, s67, 1
    s_cbranch_scc0 L_c_probe
    v_mov_b32 v13, s66
    v_mov_b32 v14, 1
    ds_write_b32 v2, v13 offset:144
    ds_write_b32 v2, v14 offset:32
L_c_noprobe:
    s_cmp_eq_u32 s9, 1
    s_cbranch_scc1 L_c_A
    s_branch L_c_kv
L_c_B:
    v_lshrrev_b32 v3, 2, v0
    v_and_b32 v9, 6, v3
    v_bfe_u32 v10, v0, 1, 1
    s_lshl_b32 s12, s8, 1
    v_add_u32 v10, s12, v10
    v_xor_b32 v9, v9, v10
    v_lshlrev_b32 v9, 4, v9
    v_lshl_add_u32 v3, v3, 7, v9
    v_and_b32 v9, 1, v0
    v_lshl_add_u32 v3, v9, 3, v3
    v_lshl_add_u32 v4, v7, 3, v1
    s_lshl_b32 s12, s8, 6
    v_lshlrev_b32 v9, 4, v7
    v_add3_u32 v9, v9, s12, v1
    s_mov_b32 s76, 0x00010001
    s_mov_b32 s77, 0x00010001
Lw_114:
    ds_read_b32 v14, v1 offset:48
    s_waitcnt lgkmcnt(0)
    v_readfirstlane_b32 s62, v14
    s_nop 0
    s_cmp_ge_u32 s62, 1
    s_cbranch_scc1 Ld_115
    s_cbranch_execz Ld_115
    s_sub_u32 s5, s5, 1
    s_cbranch_scc0 Lw_114
    s_branch L_done
Ld_115:
    v_add_u32 v13, 4096, v4
    ds_read2_b64 v[16:19], v13 offset0:0 offset1:4
    ds_read2_b64 v[20:23], v13 offset0:8 offset1:12
    ds_read2_b64 v[24:27], v13 offset0:16 offset1:20
    ds_read2_b64 v[28:31], v13 offset0:24 offset1:28
    ds_read2_b64 v[32:35], v13 offset0:32 offset1:36
    ds_read2_b64 v[36:39], v13 offset0:40 offset1:44
    ds_read2_b64 v[40:43], v13 offset0:48 offset1:52
    ds_read2_b64 v[44:47], v13 offset0:56 offset1:60
    s_waitcnt lgkmcnt(0)
    v_add_u32 v13, 0, v3
    v_add_u32 v12, 16384, v3
    s_cmp_ge_u32 s61, 2
    s_cbranch_scc1 Lf_116
Lw_117:
    ds_read_b32 v14, v1 offset:0
    s_waitcnt lgkmcnt(0)
    v_readfirstlane_b32 s61, v14
    s_nop 0
    s_cmp_ge_u32 s61, 2
    s_cbranch_scc1 Ld_118
    s_cbranch_execz Ld_118
    s_sub_u32 s5, s5, 1
    s_cbranch_scc0 Lw_117
    s_branch L_done
Ld_118:
Lf_116:
    ds_read_b64_tr_b16 v[192:193], v13 offset:0
    ds_read_b64_tr_b16 v[194:195], v13 offset:2048
    ds_read_b64_tr_b16 v[196:197], v13 offset:4096
    ds_read_b64_tr_b16 v[198:199], v13 offset:6144
    ds_read_b64_tr_b16 v[200:201], v13 offset:8192
    ds_read_b64_tr_b16 v[202:203], v13 offset:10240
    ds_read_b64_tr_b16 v[204:205], v13 offset:12288
    ds_read_b64_tr_b16 v[206:207], v13 offset:14336
    ds_read_b64_tr_b16 v[208:209], v12 offset:0
    ds_read_b64_tr_b16 v[210:211], v12 offset:2048
    ds_read_b64_tr_b16 v[212:213], v12 offset:4096
    ds_read_b64_tr_b16 v[214:215], v12 offset:6144
    ds_read_b64_tr_b16 v[216:217], v12 offset:8192
    ds_read_b64_tr_b16 v[218:219], v12 offset:10240
    ds_read_b64_tr_b16 v[220:221], v12 offset:12288
    ds_read_b64_tr_b16 v[222:223], v12 offset:14336
    s_waitcnt lgkmcnt(0)
    v_mov_b32 v14, 2
    ds_write_b32 v2, v14 offset:16
    v_mfma_f32_16x16x32_bf16 v[48:51], v[192:195], v[16:19], 0
    v_mfma_f32_16x16x32_bf16 v[48:51], v[196:199], v[20:23], v[48:51]
    v_mfma_f32_16x16x32_bf16 v[48:51], v[200:203], v[24:27], v[48:51]
    v_mfma_f32_16x16x32_bf16 v[48:51], v[204:207], v[28:31], v[48:51]
    v_mfma_f32_16x16x32_bf16 v[48:51], v[208:211], v[32:35], v[48:51]
    v_mfma_f32_16x16x32_bf16 v[48:51], v[212:215], v[36:39], v[48:51]
    v_mfma_f32_16x16x32_bf16 v[48:51], v[216:219], v[40:43], v[48:51]
    v_mfma_f32_16x16x32_bf16 v[48:51], v[220:223], v[44:47], v[48:51]
    v_mov_b32 v14, 1
    s_mov_b64 exec, s[76:77]
    s_nop 5
    ds_write_b128 v9, v[48:51] offset:256
    ds_write_b32 v2, v14 offset:32
    s_mov_b64 exec, -1
    s_mov_b32 s79, s61
    s_mov_b64 s[100:101], 0
    s_mov_b64 exec, 0
    s_branch L_c_q
L_c_dryB_ret:
    s_waitcnt lgkmcnt(0)
    s_mov_b64 s[100:101], -1
    s_mov_b64 exec, -1
    s_mov_b32 s58, 0
    s_mov_b32 s60, 0
    s_mov_b32 s61, s79
    v_add_u32 v13, 32768, v3
    v_add_u32 v12, 49152, v3
    s_cmp_ge_u32 s61, 4
    s_cbranch_scc1 Lf_119
Lw_120:
    ds_read_b32 v14, v1 offset:0
    s_waitcnt lgkmcnt(0)
    v_readfirstlane_b32 s61, v14
    s_nop 0
    s_cmp_ge_u32 s61, 4
    s_cbranch_scc1 Ld_121
    s_cbranch_execz Ld_121
    s_sub_u32 s5, s5, 1
    s_cbranch_scc0 Lw_120
    s_branch L_done
Ld_121:
Lf_119:
    ds_read_b64_tr_b16 v[128:129], v13 offset:0
    ds_read_b64_tr_b16 v[130:131], v13 offset:2048
    ds_read_b64_tr_b16 v[132:133], v13 offset:4096
    ds_read_b64_tr_b16 v[134:135], v13 offset:6144
    ds_read_b64_tr_b16 v[136:137], v13 offset:8192
    ds_read_b64_tr_b16 v[138:139], v13 offset:10240
    ds_read_b64_tr_b16 v[140:141], v13 offset:12288
    ds_read_b64_tr_b16 v[142:143], v13 offset:14336
    ds_read_b64_tr_b16 v[144:145], v12 offset:0
    ds_read_b64_tr_b16 v[146:147], v12 offset:2048
    ds_read_b64_tr_b16 v[148:149], v12 offset:4096
    ds_read_b64_tr_b16 v[150:151], v12 offset:6144
    ds_read_b64_tr_b16 v[152:153], v12 offset:8192
    ds_read_b64_tr_b16 v[154:155], v12 offset:10240
    ds_read_b64_tr_b16 v[156:157], v12 offset:12288
    ds_read_b64_tr_b16 v[158:159], v12 offset:14336
    s_waitcnt lgkmcnt(0)
    v_mov_b32 v14, 4
    ds_write_b32 v2, v14 offset:16
    v_add_u32 v13, 65536, v3
    v_add_u32 v12, 81920, v3
    s_cmp_ge_u32 s61, 6
    s_cbranch_scc1 Lf_122
Lw_123:
    ds_read_b32 v14, v1 offset:0
    s_waitcnt lgkmcnt(0)
    v_readfirstlane_b32 s61, v14
    s_nop 0
    s_cmp_ge_u32 s61, 6
    s_cbranch_scc1 Ld_124
    s_cbranch_execz Ld_124
    s_sub_u32 s5, s5, 1
    s_cbranch_scc0 Lw_123
    s_branch L_done
Ld_124:
Lf_122:
    ds_read_b64_tr_b16 v[160:161], v13 offset:0
    ds_read_b64_tr_b16 v[162:163], v13 offset:2048
    ds_read_b64_tr_b16 v[164:165], v13 offset:4096
    ds_read_b64_tr_b16 v[166:167], v13 offset:6144
    ds_read_b64_tr_b16 v[168:169], v13 offset:8192
    ds_read_b64_tr_b16 v[170:171], v13 offset:10240
    ds_read_b64_tr_b16 v[172:173], v13 offset:12288
    ds_read_b64_tr_b16 v[174:175], v13 offset:14336
    ds_read_b64_tr_b16 v[176:177], v12 offset:0
    ds_read_b64_tr_b16 v[178:179], v12 offset:2048
    ds_read_b64_tr_b16 v[180:181], v12 offset:4096
    ds_read_b64_tr_b16 v[182:183], v12 offset:6144
    ds_read_b64_tr_b16 v[184:185], v12 offset:8192
    ds_read_b64_tr_b16 v[186:187], v12 offset:10240
    ds_read_b64_tr_b16 v[188:189], v12 offset:12288
    ds_read_b64_tr_b16 v[190:191], v12 offset:14336
    s_waitcnt lgkmcnt(0)
    v_mov_b32 v14, 6
    ds_write_b32 v2, v14 offset:16
Lw_125:
    ds_read_b32 v14, v1 offset:52
    s_waitcnt lgkmcnt(0)
    v_readfirstlane_b32 s62, v14
    s_nop 0
    s_cmp_ge_u32 s62, 1
    s_cbranch_scc1 Ld_126
    s_cbranch_execz Ld_126
    s_sub_u32 s5, s5, 1
    s_cbranch_scc0 Lw_125
    s_branch L_done
Ld_126:
    v_add_u32 v13, 6144, v4
    ds_read2_b64 v[64:67], v13 offset0:0 offset1:4
    ds_read2_b64 v[68:71], v13 offset0:8 offset1:12
    ds_read2_b64 v[72:75], v13 offset0:16 offset1:20
    ds_read2_b64 v[76:79], v13 offset0:24 offset1:28
    ds_read2_b64 v[80:83], v13 offset0:32 offset1:36
    ds_read2_b64 v[84:87], v13 offset0:40 offset1:44
    ds_read2_b64 v[88:91], v13 offset0:48 offset1:52
    ds_read2_b64 v[92:95], v13 offset0:56 offset1:60
    s_waitcnt lgkmcnt(0)
    v_mfma_f32_16x16x32_bf16 v[48:51], v[128:131], v[64:67], 0
    v_mfma_f32_16x16x32_bf16 v[52:55], v[160:163], v[64:67], 0
    v_mfma_f32_16x16x32_bf16 v[48:51], v[132:135], v[68:71], v[48:51]
    v_mfma_f32_16x16x32_bf16 v[52:55], v[164:167], v[68:71], v[52:55]
    v_mfma_f32_16x16x32_bf16 v[48:51], v[136:139], v[72:75], v[48:51]
    v_mfma_f32_16x16x32_bf16 v[52:55], v[168:171], v[72:75], v[52:55]
    v_mfma_f32_16x16x32_bf16 v[48:51], v[140:143], v[76:79], v[48:51]
    v_mfma_f32_16x16x32_bf16 v[52:55], v[172:175], v[76:79], v[52:55]
    v_mfma_f32_16x16x32_bf16 v[48:51], v[144:147], v[80:83], v[48:51]
    v_mfma_f32_16x16x32_bf16 v[52:55], v[176:179], v[80:83], v[52:55]
    v_mfma_f32_16x16x32_bf16 v[48:51], v[148:151], v[84:87], v[48:51]
    v_mfma_f32_16x16x32_bf16 v[52:55], v[180:183], v[84:87], v[52:55]
    v_mfma_f32_16x16x32_bf16 v[48:51], v[152:155], v[88:91], v[48:51]
    v_mfma_f32_16x16x32_bf16 v[52:55], v[184:187], v[88:91], v[52:55]
    v_mfma_f32_16x16x32_bf16 v[48:51], v[156:159], v[92:95], v[48:51]
    v_mfma_f32_16x16x32_bf16 v[52:55], v[188:191], v[92:95], v[52:55]
    v_mov_b32 v14, 2
    s_mov_b64 exec, s[76:77]
    s_nop 4
    ds_write_b128 v9, v[48:51] offset:768
    ds_write_b128 v9, v[52:55] offset:1024
    ds_write_b32 v2, v14 offset:32
    s_mov_b64 exec, -1
    v_add_u32 v13, 98304, v3
    v_add_u32 v12, 114688, v3
    s_cmp_ge_u32 s61, 8
    s_cbranch_scc1 Lf_127
Lw_128:
    ds_read_b32 v14, v1 offset:0
    s_waitcnt lgkmcnt(0)
    v_readfirstlane_b32 s61, v14
    s_nop 0
    s_cmp_ge_u32 s61, 8
    s_cbranch_scc1 Ld_129
    s_cbranch_execz Ld_129
    s_sub_u32 s5, s5, 1
    s_cbranch_scc0 Lw_128
    s_branch L_done
Ld_129:
Lf_127:
    ds_read_b64_tr_b16 v[128:129], v13 offset:0
    ds_read_b64_tr_b16 v[130:131], v13 offset:2048
    ds_read_b64_tr_b16 v[132:133], v13 offset:4096
    ds_read_b64_tr_b16 v[134:135], v13 offset:6144
    ds_read_b64_tr_b16 v[136:137], v13 offset:8192
    ds_read_b64_tr_b16 v[138:139], v13 offset:10240
    ds_read_b64_tr_b16 v[140:141], v13 offset:12288
    ds_read_b64_tr_b16 v[142:143], v13 offset:14336
    ds_read_b64_tr_b16 v[144:145], v12 offset:0
    ds_read_b64_tr_b16 v[146:147], v12 offset:2048
    ds_read_b64_tr_b16 v[148:149], v12 offset:4096
    ds_read_b64_tr_b16 v[150:151], v12 offset:6144
    ds_read_b64_tr_b16 v[152:153], v12 offset:8192
    ds_read_b64_tr_b16 v[154:155], v12 offset:10240
    ds_read_b64_tr_b16 v[156:157], v12 offset:12288
    ds_read_b64_tr_b16 v[158:159], v12 offset:14336
    s_waitcnt lgkmcnt(0)
    v_mov_b32 v14, 8
    ds_write_b32 v2, v14 offset:16
    v_add_u32 v13, 131072, v3
    v_add_u32 v12, 0, v3
    s_cmp_ge_u32 s61, 10
    s_cbranch_scc1 Lf_130
Lw_131:
    ds_read_b32 v14, v1 offset:0
    s_waitcnt lgkmcnt(0)
    v_readfirstlane_b32 s61, v14
    s_nop 0
    s_cmp_ge_u32 s61, 10
    s_cbranch_scc1 Ld_132
    s_cbranch_execz Ld_132
    s_sub_u32 s5, s5, 1
    s_cbranch_scc0 Lw_131
    s_branch L_done
Ld_132:
Lf_130:
    ds_read_b64_tr_b16 v[160:161], v13 offset:0
    ds_read_b64_tr_b16 v[162:163], v13 offset:2048
    ds_read_b64_tr_b16 v[164:165], v13 offset:4096
    ds_read_b64_tr_b16 v[166:167], v13 offset:6144
    ds_read_b64_tr_b16 v[168:169], v13 offset:8192
    ds_read_b64_tr_b16 v[170:171], v13 offset:10240
    ds_read_b64_tr_b16 v[172:173], v13 offset:12288
    ds_read_b64_tr_b16 v[174:175], v13 offset:14336
    ds_read_b64_tr_b16 v[176:177], v12 offset:0
    ds_read_b64_tr_b16 v[178:179], v12 offset:2048
    ds_read_b64_tr_b16 v[180:181], v12 offset:4096
    ds_read_b64_tr_b16 v[182:183], v12 offset:6144
    ds_read_b64_tr_b16 v[184:185], v12 offset:8192
    ds_read_b64_tr_b16 v[186:187], v12 offset:10240
    ds_read_b64_tr_b16 v[188:189], v12 offset:12288
    ds_read_b64_tr_b16 v[190:191], v12 offset:14336
    s_waitcnt lgkmcnt(0)
    v_mov_b32 v14, 10
    ds_write_b32 v2, v14 offset:16
    v_mfma_f32_16x16x32_bf16 v[48:51], v[128:131], v[16:19], 0
    v_mfma_f32_16x16x32_bf16 v[52:55], v[160:163], v[16:19], 0
    v_mfma_f32_16x16x32_bf16 v[48:51], v[132:135], v[20:23], v[48:51]
    v_mfma_f32_16x16x32_bf16 v[52:55], v[164:167], v[20:23], v[52:55]
    v_mfma_f32_16x16x32_bf16 v[48:51], v[136:139], v[24:27], v[48:51]
    v_mfma_f32_16x16x32_bf16 v[52:55], v[168:171], v[24:27], v[52:55]
    v_mfma_f32_16x16x32_bf16 v[48:51], v[140:143], v[28:31], v[48:51]
    v_mfma_f32_16x16x32_bf16 v[52:55], v[172:175], v[28:31], v[52:55]
    v_mfma_f32_16x16x32_bf16 v[48:51], v[144:147], v[32:35], v[48:51]
    v_mfma_f32_16x16x32_bf16 v[52:55], v[176:179], v[32:35], v[52:55]
    v_mfma_f32_16x16x32_bf16 v[48:51], v[148:151], v[36:39], v[48:51]
    v_mfma_f32_16x16x32_bf16 v[52:55], v[180:183], v[36:39], v[52:55]
    v_mfma_f32_16x16x32_bf16 v[48:51], v[152:155], v[40:43], v[48:51]
    v_mfma_f32_16x16x32_bf16 v[52:55], v[184:187], v[40:43], v[52:55]
    v_mfma_f32_16x16x32_bf16 v[48:51], v[156:159], v[44:47], v[48:51]
    v_mfma_f32_16x16x32_bf16 v[52:55], v[188:191], v[44:47], v[52:55]
    v_mov_b32 v14, 3
    s_mov_b64 exec, s[76:77]
    s_nop 4
    ds_write_b128 v9, v[48:51] offset:1280
    ds_write_b128 v9, v[52:55] offset:1536
    ds_write_b32 v2, v14 offset:32
    s_mov_b64 exec, -1
    s_mov_b32 s60, 10
    s_mov_b32 s58, 16384
    v_add_u32 v13, s58, v5
    s_add_u32 s60, s60, 1
    s_add_u32 s58, s58, 16384
    s_cmp_eq_u32 s58, 147456
    s_cselect_b32 s58, 0, s58
    s_cmp_ge_u32 s61, s60
    s_cbranch_scc1 Lf_133
Lw_134:
    ds_read_b32 v14, v1 offset:0
    s_waitcnt lgkmcnt(0)
    v_readfirstlane_b32 s61, v14
    s_nop 0
    s_cmp_ge_u32 s61, s60
    s_cbranch_scc1 Ld_135
    s_cbranch_execz Ld_135
    s_sub_u32 s5, s5, 1
    s_cbranch_scc0 Lw_134
    s_branch L_done
Ld_135:
Lf_133:
    ds_read_b64 v[64:65], v13 offset:0
    ds_read_b64 v[66:67], v13 offset:2048
    ds_read_b64 v[68:69], v13 offset:4096
    ds_read_b64 v[70:71], v13 offset:6144
    ds_read_b64 v[72:73], v13 offset:8192
    ds_read_b64 v[74:75], v13 offset:10240
    ds_read_b64 v[76:77], v13 offset:12288
    ds_read_b64 v[78:79], v13 offset:14336
    s_waitcnt lgkmcnt(0)
    v_mov_b32 v14, s60
    ds_write_b32 v2, v14 offset:16
    v_perm_b32 v192, v66, v64, s70
    v_perm_b32 v193, v66, v64, s71
    v_perm_b32 v194, v67, v65, s70
    v_perm_b32 v195, v67, v65, s71
    v_perm_b32 v196, v70, v68, s70
    v_perm_b32 v197, v70, v68, s71
    v_perm_b32 v198, v71, v69, s70
    v_perm_b32 v199, v71, v69, s71
    v_perm_b32 v200, v74, v72, s70
    v_perm_b32 v201, v74, v72, s71
    v_perm_b32 v202, v75, v73, s70
    v_perm_b32 v203, v75, v73, s71
    v_perm_b32 v204, v78, v76, s70
    v_perm_b32 v205, v78, v76, s71
    v_perm_b32 v206, v79, v77, s70
    v_perm_b32 v207, v79, v77, s71
    v_add_u32 v13, s58, v5
    s_add_u32 s60, s60, 1
    s_add_u32 s58, s58, 16384
    s_cmp_eq_u32 s58, 147456
    s_cselect_b32 s58, 0, s58
    s_cmp_ge_u32 s61, s60
    s_cbranch_scc1 Lf_136
Lw_137:
    ds_read_b32 v14, v1 offset:0
    s_waitcnt lgkmcnt(0)
    v_readfirstlane_b32 s61, v14
    s_nop 0
    s_cmp_ge_u32 s61, s60
    s_cbranch_scc1 Ld_138
    s_cbranch_execz Ld_138
    s_sub_u32 s5, s5, 1
    s_cbranch_scc0 Lw_137
    s_branch L_done
Ld_138:
Lf_136:
    ds_read_b64 v[64:65], v13 offset:0
    ds_read_b64 v[66:67], v13 offset:2048
    ds_read_b64 v[68:69], v13 offset:4096
    ds_read_b64 v[70:71], v13 offset:6144
    ds_read_b64 v[72:73], v13 offset:8192
    ds_read_b64 v[74:75], v13 offset:10240
    ds_read_b64 v[76:77], v13 offset:12288
    ds_read_b64 v[78:79], v13 offset:14336
    s_waitcnt lgkmcnt(0)
    v_mov_b32 v14, s60
    ds_write_b32 v2, v14 offset:16
    v_perm_b32 v208, v66, v64, s70
    v_perm_b32 v209, v66, v64, s71
    v_perm_b32 v210, v67, v65, s70
    v_perm_b32 v211, v67, v65, s71
    v_perm_b32 v212, v70, v68, s70
    v_perm_b32 v213, v70, v68, s71
    v_perm_b32 v214, v71, v69, s70
    v_perm_b32 v215, v71, v69, s71
    v_perm_b32 v216, v74, v72, s70
    v_perm_b32 v217, v74, v72, s71
    v_perm_b32 v218, v75, v73, s70
    v_perm_b32 v219, v75, v73, s71
    v_perm_b32 v220, v78, v76, s70
    v_perm_b32 v221, v78, v76, s71
    v_perm_b32 v222, v79, v77, s70
    v_perm_b32 v223, v79, v77, s71
    v_add_u32 v13, s58, v5
    s_add_u32 s60, s60, 1
    s_add_u32 s58, s58, 16384
    s_cmp_eq_u32 s58, 147456
    s_cselect_b32 s58, 0, s58
    s_cmp_ge_u32 s61, s60
    s_cbranch_scc1 Lf_139
Lw_140:
    ds_read_b32 v14, v1 offset:0
    s_waitcnt lgkmcnt(0)
    v_readfirstlane_b32 s61, v14
    s_nop 0
    s_cmp_ge_u32 s61, s60
    s_cbranch_scc1 Ld_141
    s_cbranch_execz Ld_141
    s_sub_u32 s5, s5, 1
    s_cbranch_scc0 Lw_140
    s_branch L_done
Ld_141:
Lf_139:
    ds_read_b64 v[64:65], v13 offset:0
    ds_read_b64 v[66:67], v13 offset:2048
    ds_read_b64 v[68:69], v13 offset:4096
    ds_read_b64 v[70:71], v13 offset:6144
    ds_read_b64 v[72:73], v13 offset:8192
    ds_read_b64 v[74:75], v13 offset:10240
    ds_read_b64 v[76:77], v13 offset:12288
    ds_read_b64 v[78:79], v13 offset:14336
    s_waitcnt lgkmcnt(0)
    v_mov_b32 v14, s60
    ds_write_b32 v2, v14 offset:16
    v_perm_b32 v224, v66, v64, s70
    v_perm_b32 v225, v66, v64, s71
    v_perm_b32 v226, v67, v65, s70
    v_perm_b32 v227, v67, v65, s71
    v_perm_b32 v228, v70, v68, s70
    v_perm_b32 v229, v70, v68, s71
    v_perm_b32 v230, v71, v69, s70
    v_perm_b32 v231, v71, v69, s71
    v_perm_b32 v232, v74, v72, s70
    v_perm_b32 v233, v74, v72, s71
    v_perm_b32 v234, v75, v73, s70
    v_perm_b32 v235, v75, v73, s71
    v_perm_b32 v236, v78, v76, s70
    v_perm_b32 v237, v78, v76, s71
    v_perm_b32 v238, v79, v77, s70
    v_perm_b32 v239, v79, v77, s71
    v_add_u32 v13, s58, v5
    s_add_u32 s60, s60, 1
    s_add_u32 s58, s58, 16384
    s_cmp_eq_u32 s58, 147456
    s_cselect_b32 s58, 0, s58
    s_cmp_ge_u32 s61, s60
    s_cbranch_scc1 Lf_142
Lw_143:
    ds_read_b32 v14, v1 offset:0
    s_waitcnt lgkmcnt(0)
    v_readfirstlane_b32 s61, v14
    s_nop 0
    s_cmp_ge_u32 s61, s60
    s_cbranch_scc1 Ld_144
    s_cbranch_execz Ld_144
    s_sub_u32 s5, s5, 1
    s_cbranch_scc0 Lw_143
    s_branch L_done
Ld_144:
Lf_142:
    ds_read_b64 v[64:65], v13 offset:0
    ds_read_b64 v[66:67], v13 offset:2048
    ds_read_b64 v[68:69], v13 offset:4096
    ds_read_b64 v[70:71], v13 offset:6144
    ds_read_b64 v[72:73], v13 offset:8192
    ds_read_b64 v[74:75], v13 offset:10240
    ds_read_b64 v[76:77], v13 offset:12288
    ds_read_b64 v[78:79], v13 offset:14336
    s_waitcnt lgkmcnt(0)
    v_mov_b32 v14, s60
    ds_write_b32 v2, v14 offset:16
    v_perm_b32 v240, v66, v64, s70
    v_perm_b32 v241, v66, v64, s71
    v_perm_b32 v242, v67, v65, s70
    v_perm_b32 v243, v67, v65, s71
    v_perm_b32 v244, v70, v68, s70
    v_perm_b32 v245, v70, v68, s71
    v_perm_b32 v246, v71, v69, s70
    v_perm_b32 v247, v71, v69, s71
    v_perm_b32 v248, v74, v72, s70
    v_perm_b32 v249, v74, v72, s71
    v_perm_b32 v250, v75, v73, s70
    v_perm_b32 v251, v75, v73, s71
    v_perm_b32 v252, v78, v76, s70
    v_perm_b32 v253, v78, v76, s71
    v_perm_b32 v254, v79, v77, s70
    v_perm_b32 v255, v79, v77, s71
    s_branch L_c_kv
L_c_A:
    s_add_u32 s62, s3, 0
    s_cmp_ge_u32 s61, s62
    s_cbranch_scc1 Lf_145
Lw_146:
    ds_read_b32 v14, v1 offset:0
    s_waitcnt lgkmcnt(0)
    v_readfirstlane_b32 s61, v14
    s_nop 0
    s_cmp_ge_u32 s61, s62
    s_cbranch_scc1 Ld_147
    s_cbranch_execz Ld_147
    s_sub_u32 s5, s5, 1
    s_cbranch_scc0 Lw_146
    s_branch L_done
Ld_147:
Lf_145:
    s_add_u32 s62, s8, 0
    s_lshl_b32 s62, s62, 14
    v_add_u32 v13, s62, v3
    v_xor_b32 v12, 32, v13
    ds_read_b64_tr_b16 v[128:129], v13 offset:0
    ds_read_b64_tr_b16 v[130:131], v13 offset:1024
    ds_read_b64_tr_b16 v[132:133], v13 offset:2048
    ds_read_b64_tr_b16 v[134:135], v13 offset:3072
    ds_read_b64_tr_b16 v[136:137], v13 offset:4096
    ds_read_b64_tr_b16 v[138:139], v13 offset:5120
    ds_read_b64_tr_b16 v[140:141], v13 offset:6144
    ds_read_b64_tr_b16 v[142:143], v13 offset:7168
    ds_read_b64_tr_b16 v[144:145], v13 offset:8192
    ds_read_b64_tr_b16 v[146:147], v13 offset:9216
    ds_read_b64_tr_b16 v[148:149], v13 offset:10240
    ds_read_b64_tr_b16 v[150:151], v13 offset:11264
    ds_read_b64_tr_b16 v[152:153], v13 offset:12288
    ds_read_b64_tr_b16 v[154:155], v13 offset:13312
    ds_read_b64_tr_b16 v[156:157], v13 offset:14336
    ds_read_b64_tr_b16 v[158:159], v13 offset:15360
    ds_read_b64_tr_b16 v[160:161], v12 offset:0
    ds_read_b64_tr_b16 v[162:163], v12 offset:1024
    ds_read_b64_tr_b16 v[164:165], v12 offset:2048
    ds_read_b64_tr_b16 v[166:167], v12 offset:3072
    ds_read_b64_tr_b16 v[168:169], v12 offset:4096
    ds_read_b64_tr_b16 v[170:171], v12 offset:5120
    ds_read_b64_tr_b16 v[172:173], v12 offset:6144
    ds_read_b64_tr_b16 v[174:175], v12 offset:7168
    ds_read_b64_tr_b16 v[176:177], v12 offset:8192
    ds_read_b64_tr_b16 v[178:179], v12 offset:9216
    ds_read_b64_tr_b16 v[180:181], v12 offset:10240
    ds_read_b64_tr_b16 v[182:183], v12 offset:11264
    ds_read_b64_tr_b16 v[184:185], v12 offset:12288
    ds_read_b64_tr_b16 v[186:187], v12 offset:13312
    ds_read_b64_tr_b16 v[188:189], v12 offset:14336
    ds_read_b64_tr_b16 v[190:191], v12 offset:15360
    s_waitcnt lgkmcnt(0)
    v_mov_b32 v14, 4
    ds_write_b32 v2, v14 offset:16
    s_bfe_u32 s75, s2, 0x30003
    s_cmp_eq_u32 s75, 7
    s_cselect_b32 s75, 4, 4
    s_cmp_ge_u32 s8, s75
    s_cbranch_scc1 L_c_upskip
    s_add_u32 s62, s3, 4
    s_cmp_ge_u32 s61, s62
    s_cbranch_scc1 Lf_148
Lw_149:
    ds_read_b32 v14, v1 offset:0
    s_waitcnt lgkmcnt(0)
    v_readfirstlane_b32 s61, v14
    s_nop 0
    s_cmp_ge_u32 s61, s62
    s_cbranch_scc1 Ld_150
    s_cbranch_execz Ld_150
    s_sub_u32 s5, s5, 1
    s_cbranch_scc0 Lw_149
    s_branch L_done
Ld_150:
Lf_148:
    s_add_u32 s62, s8, 4
    s_lshl_b32 s62, s62, 14
    v_add_u32 v13, s62, v3
    v_xor_b32 v12, 32, v13
    ds_read_b64_tr_b16 v[192:193], v13 offset:0
    ds_read_b64_tr_b16 v[194:195], v13 offset:1024
    ds_read_b64_tr_b16 v[196:197], v13 offset:2048
    ds_read_b64_tr_b16 v[198:199], v13 offset:3072
    ds_read_b64_tr_b16 v[200:201], v13 offset:4096
    ds_read_b64_tr_b16 v[202:203], v13 offset:5120
    ds_read_b64_tr_b16 v[204:205], v13 offset:6144
    ds_read_b64_tr_b16 v[206:207], v13 offset:7168
    ds_read_b64_tr_b16 v[208:209], v13 offset:8192
    ds_read_b64_tr_b16 v[210:211], v13 offset:9216
    ds_read_b64_tr_b16 v[212:213], v13 offset:10240
    ds_read_b64_tr_b16 v[214:215], v13 offset:11264
    ds_read_b64_tr_b16 v[216:217], v13 offset:12288
    ds_read_b64_tr_b16 v[218:219], v13 offset:13312
    ds_read_b64_tr_b16 v[220:221], v13 offset:14336
    ds_read_b64_tr_b16 v[222:223], v13 offset:15360
    ds_read_b64_tr_b16 v[224:225], v12 offset:0
    ds_read_b64_tr_b16 v[226:227], v12 offset:1024
    ds_read_b64_tr_b16 v[228:229], v12 offset:2048
    ds_read_b64_tr_b16 v[230:231], v12 offset:3072
    ds_read_b64_tr_b16 v[232:233], v12 offset:4096
    ds_read_b64_tr_b16 v[234:235], v12 offset:5120
    ds_read_b64_tr_b16 v[236:237], v12 offset:6144
    ds_read_b64_tr_b16 v[238:239], v12 offset:7168
    ds_read_b64_tr_b16 v[240:241], v12 offset:8192
    ds_read_b64_tr_b16 v[242:243], v12 offset:9216
    ds_read_b64_tr_b16 v[244:245], v12 offset:10240
    ds_read_b64_tr_b16 v[246:247], v12 offset:11264
    ds_read_b64_tr_b16 v[248:249], v12 offset:12288
    ds_read_b64_tr_b16 v[250:251], v12 offset:13312
    ds_read_b64_tr_b16 v[252:253], v12 offset:14336
    ds_read_b64_tr_b16 v[254:255], v12 offset:15360
    s_waitcnt lgkmcnt(0)
L_c_upskip:
    s_add_u32 s60, s75, 4
    s_lshl_b32 s58, s60, 14
    v_mov_b32 v14, s60
    ds_write_b32 v2, v14 offset:16
L_c_kv:
L_c_q:
Lw_151:
    ds_read_b32 v14, v1 offset:56
    s_waitcnt lgkmcnt(0)
    v_readfirstlane_b32 s62, v14
    s_nop 0
    s_cmp_ge_u32 s62, 1
    s_cbranch_scc1 Ld_152
    s_cbranch_execz Ld_152
    s_sub_u32 s5, s5, 1
    s_cbranch_scc0 Lw_151
    s_branch L_done
Ld_152:
    v_and_b32 v9, 7, v0
    v_lshlrev_b32 v9, 8, v9
    v_lshl_add_u32 v9, v7, 4, v9
    v_add_u32 v9, v9, v1
    ds_read_b64 v[10:11], v1 offset:128
    ds_read_b128 v[48:51], v9 offset:10240
    ds_read_b128 v[52:55], v9 offset:10304
    ds_read_b128 v[56:59], v9 offset:10368
    ds_read_b128 v[60:63], v9 offset:10432
    s_waitcnt lgkmcnt(0)
    v_readfirstlane_b32 s6, v10
    v_readfirstlane_b32 s7, v11
    s_and_b32 s83, s6, 0xff
    s_mul_i32 s83, s83, 0x01010100
    s_xor_b32 s83, s83, s6
    s_mov_b32 s82, 0xffffff00
    v_cndmask_b32 v16, 0, v48, s[10:11]
    v_cndmask_b32 v32, v48, 0, s[10:11]
    v_cndmask_b32 v17, 0, v49, s[10:11]
    v_cndmask_b32 v33, v49, 0, s[10:11]
    v_cndmask_b32 v18, 0, v50, s[10:11]
    v_cndmask_b32 v34, v50, 0, s[10:11]
    v_cndmask_b32 v19, 0, v51, s[10:11]
    v_cndmask_b32 v35, v51, 0, s[10:11]
    v_cndmask_b32 v20, 0, v52, s[10:11]
    v_cndmask_b32 v36, v52, 0, s[10:11]
    v_cndmask_b32 v21, 0, v53, s[10:11]
    v_cndmask_b32 v37, v53, 0, s[10:11]
    v_cndmask_b32 v22, 0, v54, s[10:11]
    v_cndmask_b32 v38, v54, 0, s[10:11]
    v_cndmask_b32 v23, 0, v55, s[10:11]
    v_cndmask_b32 v39, v55, 0, s[10:11]
    v_cndmask_b32 v24, 0, v56, s[10:11]
    v_cndmask_b32 v40, v56, 0, s[10:11]
    v_cndmask_b32 v25, 0, v57, s[10:11]
    v_cndmask_b32 v41, v57, 0, s[10:11]
    v_cndmask_b32 v26, 0, v58, s[10:11]
    v_cndmask_b32 v42, v58, 0, s[10:11]
    v_cndmask_b32 v27, 0, v59, s[10:11]
    v_cndmask_b32 v43, v59, 0, s[10:11]
    v_cndmask_b32 v28, 0, v60, s[10:11]
    v_cndmask_b32 v44, v60, 0, s[10:11]
    v_cndmask_b32 v29, 0, v61, s[10:11]
    v_cndmask_b32 v45, v61, 0, s[10:11]
    v_cndmask_b32 v30, 0, v62, s[10:11]
    v_cndmask_b32 v46, v62, 0, s[10:11]
    v_cndmask_b32 v31, 0, v63, s[10:11]
    v_cndmask_b32 v47, v63, 0, s[10:11]
    v_or_b32 v13, 0, v7
    v_xor_b32 v13, v13, v8
    v_lshlrev_b32 v13, 4, v13
    v_lshl_add_u32 v9, v8, 8, v13
    v_or_b32 v13, 4, v7
    v_xor_b32 v13, v13, v8
    v_lshlrev_b32 v13, 4, v13
    v_lshl_add_u32 v10, v8, 8, v13
    v_or_b32 v13, 8, v7
    v_xor_b32 v13, v13, v8
    v_lshlrev_b32 v13, 4, v13
    v_lshl_add_u32 v11, v8, 8, v13
    v_or_b32 v13, 12, v7
    v_xor_b32 v13, v13, v8
    v_lshlrev_b32 v13, 4, v13
    v_lshl_add_u32 v12, v8, 8, v13
    v_lshrrev_b32 v13, 2, v0
    v_and_b32 v14, 7, v13
    v_lshlrev_b32 v14, 1, v14
    v_bfe_u32 v126, v0, 1, 1
    s_lshl_b32 s12, s8, 2
    v_add_u32 v126, s12, v126
    v_xor_b32 v126, v126, v14
    v_lshlrev_b32 v126, 4, v126
    v_lshl_add_u32 v126, v13, 8, v126
    v_and_b32 v14, 1, v0
    v_lshl_add_u32 v126, v14, 3, v126
    v_xor_b32 v127, 32, v126
    v_and_b32 v13, 7, v0
    v_lshlrev_b32 v13, 16, v13
    v_bfe_u32 v14, v0, 3, 1
    v_lshl_add_u32 v13, v14, 6, v13
    v_lshl_add_u32 v3, v7, 4, v13
    s_lshr_b32 s66, s2, 6
    s_lshl_b32 s66, s66, 5
    s_add_u32 s66, s66, s8
    s_lshl_b32 s66, s66, 14
    s_and_b32 s67, s2, 63
    s_lshl_b32 s67, s67, 7
    s_add_u32 s66, s66, s67
    s_add_u32 s66, s66, 2097152
    s_lshr_b32 s12, s2, 6
    s_lshl_b32 s12, s12, 14
    s_add_u32 s67, s67, s12
    s_add_u32 s67, s67, 458752
    s_mov_b32 s64, -1
    s_mov_b32 s68, s8
    v_mov_b32 v108, 0
    v_mov_b32 v109, 0
    v_mov_b32 v110, 0
    v_mov_b32 v111, 0
    v_mov_b32 v112, 0
    v_mov_b32 v113, 0
    v_mov_b32 v114, 0
    v_mov_b32 v115, 0
    v_mov_b32 v116, 0
    v_mov_b32 v117, 0
    v_mov_b32 v118, 0
    v_mov_b32 v119, 0
    v_mov_b32 v120, 0
    v_mov_b32 v121, 0
    v_mov_b32 v122, 0
    v_mov_b32 v123, 0
    v_mov_b32 v124, 0xff7fffff
    v_mov_b32 v125, 0
    s_mov_b32 s65, 0
    s_mov_b32 s69, 0
    v_lshlrev_b32 v13, 3, v7
    v_bfe_u32 v13, s83, v13, 8
    s_branch L_c_top
L_c_sel:
    v_and_b32 v86, 7, v0
    v_lshl_add_u32 v86, v86, 4, v2
    s_branch Lh_154
Lr_153:
    s_sub_u32 s5, s5, 1
    s_cbranch_scc1 L_done
Lh_154:
    ds_read_b32 v14, v1 offset:8
    ds_read_b32 v87, v86 offset:3840
    s_waitcnt lgkmcnt(1)
    v_cmp_gt_u32 vcc, 1, v14
    s_cbranch_vccnz Lr_153
    s_mov_b32 s69, 1
    s_waitcnt lgkmcnt(0)
    v_add_u32 v3, v3, v87
L_c_top:
    ds_read_b96 v[64:66], v1 offset:0
    s_add_u32 s62, s60, 1
    s_waitcnt lgkmcnt(0)
    v_readfirstlane_b32 s61, v64
    v_readfirstlane_b32 s64, v65
    v_readfirstlane_b32 s63, v66
    s_cbranch_execz L_c_go
    s_cmp_eq_u32 s62, s64
    s_cbranch_scc1 L_c_last
    s_cmp_ge_u32 s61, s62
    s_cbranch_scc1 L_c_go
    s_cmp_gt_u32 s63, s69
    s_cbranch_scc1 L_c_sel
    s_sub_u32 s5, s5, 1
    s_cbranch_scc0 L_c_top
    s_branch L_done
L_c_go:
    v_add_u32 v100, s58, v9
    v_add_u32 v101, s58, v10
    v_add_u32 v102, s58, v11
    v_add_u32 v103, s58, v12
    ds_read_b128 v[48:51], v100 offset:0
    ds_read_b128 v[52:55], v101 offset:0
    ds_read_b128 v[56:59], v102 offset:0
    ds_read_b128 v[60:63], v103 offset:0
    ds_read_b128 v[64:67], v100 offset:8192
    ds_read_b128 v[68:71], v101 offset:8192
    ds_read_b128 v[72:75], v102 offset:8192
    ds_read_b128 v[76:79], v103 offset:8192
    ds_read_b128 v[80:83], v100 offset:4096
    ds_read_b128 v[84:87], v101 offset:4096
    ds_read_b128 v[88:91], v102 offset:4096
    ds_read_b128 v[92:95], v103 offset:4096
    s_waitcnt lgkmcnt(11)
    v_mfma_f32_16x16x32_bf16 v[96:99], v[48:51], v[16:19], 0
    s_waitcnt lgkmcnt(10)
    v_mfma_f32_16x16x32_bf16 v[96:99], v[52:55], v[20:23], v[96:99]
    s_waitcnt lgkmcnt(9)
    v_mfma_f32_16x16x32_bf16 v[96:99], v[56:59], v[24:27], v[96:99]
    s_waitcnt lgkmcnt(8)
    v_mfma_f32_16x16x32_bf16 v[96:99], v[60:63], v[28:31], v[96:99]
    ds_read_b128 v[48:51], v100 offset:12288
    ds_read_b128 v[52:55], v101 offset:12288
    ds_read_b128 v[56:59], v102 offset:12288
    ds_read_b128 v[60:63], v103 offset:12288
    s_waitcnt lgkmcnt(11)
    v_mfma_f32_16x16x32_bf16 v[96:99], v[64:67], v[32:35], v[96:99]
    s_waitcnt lgkmcnt(10)
    v_mfma_f32_16x16x32_bf16 v[96:99], v[68:71], v[36:39], v[96:99]
    s_waitcnt lgkmcnt(9)
    v_mfma_f32_16x16x32_bf16 v[96:99], v[72:75], v[40:43], v[96:99]
    s_waitcnt lgkmcnt(8)
    v_mfma_f32_16x16x32_bf16 v[96:99], v[76:79], v[44:47], v[96:99]
    s_waitcnt lgkmcnt(7)
    v_mfma_f32_16x16x32_bf16 v[100:103], v[80:83], v[16:19], 0
    s_waitcnt lgkmcnt(6)
    v_mfma_f32_16x16x32_bf16 v[100:103], v[84:87], v[20:23], v[100:103]
    s_waitcnt lgkmcnt(5)
    v_mfma_f32_16x16x32_bf16 v[100:103], v[88:91], v[24:27], v[100:103]
    s_waitcnt lgkmcnt(4)
    v_mfma_f32_16x16x32_bf16 v[100:103], v[92:95], v[28:31], v[100:103]
    v_cvt_pk_bf16_f32 v97, v96, v97
    v_cvt_pk_bf16_f32 v99, v98, v99
    s_waitcnt lgkmcnt(3)
    v_mfma_f32_16x16x32_bf16 v[100:103], v[48:51], v[32:35], v[100:103]
    v_lshlrev_b32 v96, 16, v97
    v_and_b32 v97, 0xffff0000, v97
    s_waitcnt lgkmcnt(2)
    v_mfma_f32_16x16x32_bf16 v[100:103], v[52:55], v[36:39], v[100:103]
    v_lshlrev_b32 v98, 16, v99
    v_and_b32 v99, 0xffff0000, v99
    s_waitcnt lgkmcnt(1)
    v_mfma_f32_16x16x32_bf16 v[100:103], v[56:59], v[40:43], v[100:103]
    v_pk_mul_f32 v[96:97], v[96:97], s[72:73]
    v_pk_mul_f32 v[98:99], v[98:99], s[72:73]
    s_waitcnt lgkmcnt(0)
    v_mfma_f32_16x16x32_bf16 v[100:103], v[60:63], v[44:47], v[100:103]
    v_mov_b32 v14, s62
    ds_write_b32 v2, v14 offset:16
    v_cvt_pk_bf16_f32 v97, v96, v97
    v_cvt_pk_bf16_f32 v99, v98, v99
    v_lshlrev_b32 v96, 16, v97
    v_and_b32 v97, 0xffff0000, v97
    v_lshlrev_b32 v98, 16, v99
    v_and_b32 v99, 0xffff0000, v99
    v_max_f32 v64, v96, v97
    v_max3_f32 v64, v64, v98, v99
    v_cvt_pk_bf16_f32 v101, v100, v101
    v_cvt_pk_bf16_f32 v103, v102, v103
    v_lshlrev_b32 v100, 16, v101
    v_and_b32 v101, 0xffff0000, v101
    v_lshlrev_b32 v102, 16, v103
    v_and_b32 v103, 0xffff0000, v103
    v_pk_mul_f32 v[100:101], v[100:101], s[72:73]
    v_pk_mul_f32 v[102:103], v[102:103], s[72:73]
    v_cvt_pk_bf16_f32 v101, v100, v101
    v_cvt_pk_bf16_f32 v103, v102, v103
    v_lshlrev_b32 v100, 16, v101
    v_and_b32 v101, 0xffff0000, v101
    v_lshlrev_b32 v102, 16, v103
    v_and_b32 v103, 0xffff0000, v103
    v_max3_f32 v64, v64, v100, v101
    v_max3_f32 v64, v64, v102, v103
    s_add_u32 s60, s60, 1
    s_add_u32 s58, s58, 16384
    v_max_f32_dpp v64, v64, v64 row_ror:8 row_mask:0xf bank_mask:0xf
    v_mov_b32 v65, v64
    s_cmp_eq_u32 s58, 147456
    s_cselect_b32 s58, 0, s58
    v_permlane16_swap_b32 v64, v65
    v_max_f32 v64, v64, v65
    v_mov_b32 v65, v64
    s_nop 1
    v_permlane32_swap_b32 v64, v65
    v_max_f32 v64, v64, v65
    v_mul_f32 v64, s74, v64
    v_max_f32 v64, v64, v124
    v_sub_f32 v66, v124, v64
    v_mov_b32 v124, v64
    v_exp_f32 v66, v66
    v_fma_f32 v96, v96, s74, -v124
    v_fma_f32 v97, v97, s74, -v124
    v_fma_f32 v98, v98, s74, -v124
    v_fma_f32 v99, v99, s74, -v124
    v_fma_f32 v100, v100, s74, -v124
    v_fma_f32 v101, v101, s74, -v124
    v_fma_f32 v102, v102, s74, -v124
    v_fma_f32 v103, v103, s74, -v124
    v_exp_f32 v96, v96
    v_exp_f32 v97, v97
    v_exp_f32 v98, v98
    v_exp_f32 v99, v99
    v_exp_f32 v100, v100
    v_exp_f32 v101, v101
    v_exp_f32 v102, v102
    v_exp_f32 v103, v103
    v_pk_add_f32 v[68:69], v[96:97], v[98:99]
    v_pk_add_f32 v[70:71], v[100:101], v[102:103]
    v_pk_add_f32 v[68:69], v[68:69], v[70:71]
    v_add_f32 v68, v68, v69
    v_fma_f32 v125, v125, v66, v68
    s_cbranch_execz L_c_last
    s_cmp_eq_u32 s65, 0
    s_cbranch_scc1 L_c_pvdone
    s_add_u32 s62, s60, 2
    s_cmp_lg_u32 s62, s64
    s_cbranch_scc1 L_c_pv
    s_branch L_c_mlq
L_c_sel2:
    v_and_b32 v86, 7, v0
    v_lshl_add_u32 v86, v86, 4, v2
    s_branch Lh_156
Lr_155:
    s_sub_u32 s5, s5, 1
    s_cbranch_scc1 L_done
Lh_156:
    ds_read_b32 v14, v1 offset:8
    ds_read_b32 v87, v86 offset:3840
    s_waitcnt lgkmcnt(1)
    v_cmp_gt_u32 vcc, 1, v14
    s_cbranch_vccnz Lr_155
    s_mov_b32 s69, 1
    s_waitcnt lgkmcnt(0)
    v_add_u32 v3, v3, v87
L_c_last:
    s_mov_b32 s65, 2
    s_cbranch_execz L_c_ml
    s_cmp_eq_u32 s69, 0
    s_cbranch_scc1 L_c_sel2
L_c_mlq:
    s_cmp_lg_u32 s68, 0
    s_cbranch_scc1 L_c_pv
L_c_ml:
    s_nop 1
    v_add_f32_dpp v81, v125, v125 row_ror:8 row_mask:0xf bank_mask:0xf
    v_mov_b32 v84, v81
    s_nop 1
    v_permlane16_swap_b32 v81, v84
    v_add_f32 v81, v81, v84
    v_mov_b32 v84, v81
    s_nop 1
    v_permlane32_swap_b32 v81, v84
    v_add_f32 v81, v81, v84
    v_mov_b32 v80, v124
    v_mov_b32 v82, s6
    v_mov_b32 v83, s7
    v_and_b32 v84, 8, v0
    v_mul_u32_u24 v84, 1008, v84
    v_lshl_add_u32 v84, v0, 4, v84
    s_and_b64 exec, exec, 0xffff
    s_cbranch_execz Lx_157
    buffer_store_dwordx4 v[80:83], v84, s[44:47], s67 offen sc1
Lx_157:
    s_mov_b64 exec, s[100:101]
    s_mov_b32 s68, 1
    v_mov_b32 v14, 1
    ds_write_b32 v1, v14 offset:68
L_c_pv:
    v_add_u32 v72, s58, v126
    v_add_u32 v73, s58, v127
    s_add_u32 s60, s60, 1
    s_add_u32 s58, s58, 16384
    s_cmp_eq_u32 s58, 147456
    s_cselect_b32 s58, 0, s58
    s_cmp_ge_u32 s61, s60
    s_cbranch_scc1 Lf_158
Lw_159:
    ds_read_b32 v14, v1 offset:0
    s_waitcnt lgkmcnt(0)
    v_readfirstlane_b32 s61, v14
    s_nop 0
    s_cmp_ge_u32 s61, s60
    s_cbranch_scc1 Ld_160
    s_cbranch_execz Ld_160
    s_sub_u32 s5, s5, 1
    s_cbranch_scc0 Lw_159
    s_branch L_done
Ld_160:
Lf_158:
    ds_read_b64_tr_b16 v[48:49], v72 offset:0
    ds_read_b64_tr_b16 v[50:51], v72 offset:4096
    ds_read_b64_tr_b16 v[52:53], v72 offset:8192
    ds_read_b64_tr_b16 v[54:55], v72 offset:12288
    ds_read_b64_tr_b16 v[56:57], v73 offset:0
    ds_read_b64_tr_b16 v[58:59], v73 offset:4096
    ds_read_b64_tr_b16 v[60:61], v73 offset:8192
    ds_read_b64_tr_b16 v[62:63], v73 offset:12288
L_c_pvm:
    s_waitcnt lgkmcnt(6)
    v_mfma_f32_16x16x32_bf16 v[108:111], v[48:51], v[104:107], v[108:111]
    s_waitcnt lgkmcnt(4)
    v_mfma_f32_16x16x32_bf16 v[112:115], v[52:55], v[104:107], v[112:115]
    s_waitcnt lgkmcnt(2)
    v_mfma_f32_16x16x32_bf16 v[116:119], v[56:59], v[104:107], v[116:119]
    s_waitcnt lgkmcnt(0)
    v_mfma_f32_16x16x32_bf16 v[120:123], v[60:63], v[104:107], v[120:123]
    s_cmp_eq_u32 s65, 2
    s_cbranch_scc1 L_c_fin
    v_mov_b32 v14, s60
    ds_write_b32 v2, v14 offset:16
L_c_pvdone:
    s_mov_b32 s65, 1
    v_cvt_pk_bf16_f32 v104, v96, v97
    v_cvt_pk_bf16_f32 v105, v98, v99
    v_cvt_pk_bf16_f32 v106, v100, v101
    v_cvt_pk_bf16_f32 v107, v102, v103
    v_pk_mul_f32 v[108:109], v[108:109], v[66:67] op_sel_hi:[1,0]
    v_pk_mul_f32 v[110:111], v[110:111], v[66:67] op_sel_hi:[1,0]
    v_pk_mul_f32 v[112:113], v[112:113], v[66:67] op_sel_hi:[1,0]
    v_pk_mul_f32 v[114:115], v[114:115], v[66:67] op_sel_hi:[1,0]
    v_pk_mul_f32 v[116:117], v[116:117], v[66:67] op_sel_hi:[1,0]
    v_pk_mul_f32 v[118:119], v[118:119], v[66:67] op_sel_hi:[1,0]
    v_pk_mul_f32 v[120:121], v[120:121], v[66:67] op_sel_hi:[1,0]
    v_pk_mul_f32 v[122:123], v[122:123], v[66:67] op_sel_hi:[1,0]
    s_add_u32 s62, s60, 1
    s_cmp_eq_u32 s62, s64
    s_cbranch_scc1 L_c_last
    s_branch L_c_top
L_c_fin:
    s_nop 5
    v_cndmask_b32 v52, v120, v108, s[10:11]
    v_cndmask_b32 v56, v112, v116, s[10:11]
    v_cndmask_b32 v53, v121, v109, s[10:11]
    v_cndmask_b32 v57, v113, v117, s[10:11]
    v_cndmask_b32 v54, v122, v110, s[10:11]
    v_cndmask_b32 v58, v114, v118, s[10:11]
    v_cndmask_b32 v55, v123, v111, s[10:11]
    v_cndmask_b32 v59, v115, v119, s[10:11]
    v_add_f32_dpp v48, v56, v52 row_ror:8 row_mask:0xf bank_mask:0xf
    v_add_f32_dpp v49, v57, v53 row_ror:8 row_mask:0xf bank_mask:0xf
    v_add_f32_dpp v50, v58, v54 row_ror:8 row_mask:0xf bank_mask:0xf
    v_add_f32_dpp v51, v59, v55 row_ror:8 row_mask:0xf bank_mask:0xf
    v_and_or_b32 v48, v48, s82, v13
    s_cbranch_execz Lx_161
    buffer_store_dwordx4 v[48:51], v3, s[44:47], s66 offen sc1
Lx_161:
    v_mov_b32 v14, s60
    ds_write_b32 v2, v14 offset:16
    v_lshrrev_b32 v9, 3, v0
    s_lshl_b32 s12, s8, 5
    v_lshl_add_u32 v11, v9, 2, v1
    v_add_u32 v11, s12, v11
    ds_read_b32 v11, v11 offset:3968
    ds_read_b64 v[12:13], v1 offset:136
    v_lshlrev_b32 v9, 15, v9
    v_and_b32 v10, 7, v0
    v_lshl_add_u32 v9, v10, 4, v9
    v_and_b32 v3, 3, v0
    v_lshlrev_b32 v3, 3, v3
    v_bfe_u32 v3, s83, v3, 8
    s_lshl_b32 s66, s8, 18
    s_and_b32 s67, s4, 63
    s_lshl_b32 s67, s67, 7
    s_add_u32 s66, s66, s67
    s_lshr_b32 s67, s4, 6
    s_lshl_b32 s67, s67, 14
    s_add_u32 s66, s66, s67
    s_waitcnt lgkmcnt(0)
    v_add_u32 v9, v9, v11
    v_readfirstlane_b32 s81, v12
    v_readfirstlane_b32 s80, v13
    s_cmp_eq_u32 s9, 1
    s_cbranch_scc1 L_c_mlp
    s_cmp_eq_u32 s9, 2
    s_cbranch_scc1 L_c_end
    s_add_u32 s66, s66, 1048576
    s_lshl_b32 s67, s4, 14
    s_lshl_b32 s68, s8, 11
    s_add_u32 s67, s67, s68
    s_add_u32 s67, s67, s80
    s_add_u32 s67, s67, 2097152
    v_lshrrev_b32 v12, 3, v0
    v_lshlrev_b32 v11, 4, v0
    s_lshl_b32 s12, s8, 6
    v_lshl_add_u32 v12, v12, 2, v1
    v_add_u32 v12, s12, v12
    s_lshl_b32 s12, s8, 7
    v_lshl_add_u32 v10, v10, 4, v1
    v_add_u32 v10, s12, v10
    v_lshl_add_u32 v13, v8, 3, v1
    v_mov_b32 v60, 0
    v_mov_b32 v61, 0
    v_mov_b32 v62, 0
    v_mov_b32 v63, 0
    s_branch Lh_163
Lr_162:
    s_sub_u32 s5, s5, 1
    s_cbranch_scc1 L_done
Lh_163:
    ds_read_b32 v14, v1 offset:76
    s_waitcnt lgkmcnt(0)
    v_cmp_gt_u32 vcc, 2, v14
    s_cbranch_vccnz Lr_162
    s_branch Lh_165
Lr_164:
    s_sub_u32 s5, s5, 16
    s_cbranch_scc1 L_done
Lh_165:
    s_cbranch_execz Lx_166
    buffer_load_dwordx4 v[64:67], v11, s[44:47], s67 offen offset:0 sc1
    buffer_load_dwordx4 v[68:71], v11, s[44:47], s67 offen offset:1024 sc1
Lx_166:
    s_branch Lh_168
Lr_167:
    s_sub_u32 s5, s5, 1
    s_cbranch_scc1 L_done
Lh_168:
    ds_read_b32 v14, v1 offset:76
    ds_read_b32 v72, v12 offset:3584
    ds_read_b32 v74, v12 offset:3616
    s_waitcnt lgkmcnt(2)
    v_cmp_gt_u32 vcc, 2, v14
    s_cbranch_vccnz Lr_167
    s_waitcnt lgkmcnt(0)
    s_waitcnt vmcnt(1)
    v_xor_b32 v64, v3, v64
    s_waitcnt vmcnt(0)
    v_xor_b32 v68, v3, v68
    v_or_b32 v76, v64, v68
    v_and_b32 v76, 0xff, v76
    v_cmp_ne_u32 vcc, 0, v76
    s_cbranch_vccnz Lr_164
    v_pk_mul_f32 v[64:65], v[64:65], v[72:73] op_sel_hi:[1,0]
    v_pk_mul_f32 v[66:67], v[66:67], v[72:73] op_sel_hi:[1,0]
    v_pk_fma_f32 v[64:65], v[68:69], v[74:75], v[64:65] op_sel_hi:[1,0,1]
    v_pk_fma_f32 v[66:67], v[70:71], v[74:75], v[66:67] op_sel_hi:[1,0,1]
    v_mov_b32 v14, 4
    v_add_f32_dpp v64, v64, v64 row_ror:8 row_mask:0xf bank_mask:0xf
    v_add_f32_dpp v65, v65, v65 row_ror:8 row_mask:0xf bank_mask:0xf
    v_add_f32_dpp v66, v66, v66 row_ror:8 row_mask:0xf bank_mask:0xf
    v_add_f32_dpp v67, v67, v67 row_ror:8 row_mask:0xf bank_mask:0xf
    v_mov_b32 v68, v64
    v_mov_b32 v69, v65
    v_mov_b32 v70, v66
    v_mov_b32 v71, v67
    v_permlane16_swap_b32 v64, v68
    v_permlane16_swap_b32 v65, v69
    v_permlane16_swap_b32 v66, v70
    v_permlane16_swap_b32 v67, v71
    v_pk_add_f32 v[64:65], v[64:65], v[68:69]
    v_pk_add_f32 v[66:67], v[66:67], v[70:71]
    v_mov_b32 v68, v64
    v_mov_b32 v69, v65
    v_mov_b32 v70, v66
    v_mov_b32 v71, v67
    v_permlane32_swap_b32 v64, v68
    v_permlane32_swap_b32 v65, v69
    v_permlane32_swap_b32 v66, v70
    v_permlane32_swap_b32 v67, v71
    v_pk_add_f32 v[64:65], v[64:65], v[68:69]
    v_pk_add_f32 v[66:67], v[66:67], v[70:71]
    ds_write_b128 v10, v[64:67] offset:1792
    ds_write_b32 v2, v14 offset:32
    s_branch Lh_170
Lr_169:
    s_sub_u32 s5, s5, 1
    s_cbranch_scc1 L_done
Lh_170:
    ds_read_b128 v[76:79], v1 offset:32
    ds_read_b64 v[80:81], v13 offset:1792
    ds_read_b64 v[82:83], v13 offset:1920
    ds_read_b64 v[84:85], v13 offset:2048
    ds_read_b64 v[86:87], v13 offset:2176
    s_waitcnt lgkmcnt(4)
    v_min3_u32 v76, v76, v77, v78
    v_min_u32 v76, v76, v79
    v_cmp_gt_u32 vcc, 4, v76
    s_cbranch_vccnz Lr_169
    s_waitcnt lgkmcnt(0)
    v_pk_add_f32 v[80:81], v[80:81], v[82:83]
    v_pk_add_f32 v[84:85], v[84:85], v[86:87]
    v_pk_add_f32 v[80:81], v[80:81], v[84:85]
    v_cvt_pk_bf16_f32 v80, v80, v81
    s_nop 1
    v_dot2c_f32_bf16_dpp v60, v80, v192 row_newbcast:0 row_mask:0xf bank_mask:0xf
    v_dot2c_f32_bf16_dpp v61, v80, v193 row_newbcast:0 row_mask:0xf bank_mask:0xf
    v_dot2c_f32_bf16_dpp v62, v80, v194 row_newbcast:0 row_mask:0xf bank_mask:0xf
    v_dot2c_f32_bf16_dpp v63, v80, v195 row_newbcast:0 row_mask:0xf bank_mask:0xf
    v_dot2c_f32_bf16_dpp v60, v80, v196 row_newbcast:1 row_mask:0xf bank_mask:0xf
    v_dot2c_f32_bf16_dpp v61, v80, v197 row_newbcast:1 row_mask:0xf bank_mask:0xf
    v_dot2c_f32_bf16_dpp v62, v80, v198 row_newbcast:1 row_mask:0xf bank_mask:0xf
    v_dot2c_f32_bf16_dpp v63, v80, v199 row_newbcast:1 row_mask:0xf bank_mask:0xf
    v_dot2c_f32_bf16_dpp v60, v80, v200 row_newbcast:2 row_mask:0xf bank_mask:0xf
    v_dot2c_f32_bf16_dpp v61, v80, v201 row_newbcast:2 row_mask:0xf bank_mask:0xf
    v_dot2c_f32_bf16_dpp v62, v80, v202 row_newbcast:2 row_mask:0xf bank_mask:0xf
    v_dot2c_f32_bf16_dpp v63, v80, v203 row_newbcast:2 row_mask:0xf bank_mask:0xf
    v_dot2c_f32_bf16_dpp v60, v80, v204 row_newbcast:3 row_mask:0xf bank_mask:0xf
    v_dot2c_f32_bf16_dpp v61, v80, v205 row_newbcast:3 row_mask:0xf bank_mask:0xf
    v_dot2c_f32_bf16_dpp v62, v80, v206 row_newbcast:3 row_mask:0xf bank_mask:0xf
    v_dot2c_f32_bf16_dpp v63, v80, v207 row_newbcast:3 row_mask:0xf bank_mask:0xf
    v_dot2c_f32_bf16_dpp v60, v80, v208 row_newbcast:4 row_mask:0xf bank_mask:0xf
    v_dot2c_f32_bf16_dpp v61, v80, v209 row_newbcast:4 row_mask:0xf bank_mask:0xf
    v_dot2c_f32_bf16_dpp v62, v80, v210 row_newbcast:4 row_mask:0xf bank_mask:0xf
    v_dot2c_f32_bf16_dpp v63, v80, v211 row_newbcast:4 row_mask:0xf bank_mask:0xf
    v_dot2c_f32_bf16_dpp v60, v80, v212 row_newbcast:5 row_mask:0xf bank_mask:0xf
    v_dot2c_f32_bf16_dpp v61, v80, v213 row_newbcast:5 row_mask:0xf bank_mask:0xf
    v_dot2c_f32_bf16_dpp v62, v80, v214 row_newbcast:5 row_mask:0xf bank_mask:0xf
    v_dot2c_f32_bf16_dpp v63, v80, v215 row_newbcast:5 row_mask:0xf bank_mask:0xf
    v_dot2c_f32_bf16_dpp v60, v80, v216 row_newbcast:6 row_mask:0xf bank_mask:0xf
    v_dot2c_f32_bf16_dpp v61, v80, v217 row_newbcast:6 row_mask:0xf bank_mask:0xf
    v_dot2c_f32_bf16_dpp v62, v80, v218 row_newbcast:6 row_mask:0xf bank_mask:0xf
    v_dot2c_f32_bf16_dpp v63, v80, v219 row_newbcast:6 row_mask:0xf bank_mask:0xf
    v_dot2c_f32_bf16_dpp v60, v80, v220 row_newbcast:7 row_mask:0xf bank_mask:0xf
    v_dot2c_f32_bf16_dpp v61, v80, v221 row_newbcast:7 row_mask:0xf bank_mask:0xf
    v_dot2c_f32_bf16_dpp v62, v80, v222 row_newbcast:7 row_mask:0xf bank_mask:0xf
    v_dot2c_f32_bf16_dpp v63, v80, v223 row_newbcast:7 row_mask:0xf bank_mask:0xf
    v_dot2c_f32_bf16_dpp v60, v80, v224 row_newbcast:8 row_mask:0xf bank_mask:0xf
    v_dot2c_f32_bf16_dpp v61, v80, v225 row_newbcast:8 row_mask:0xf bank_mask:0xf
    v_dot2c_f32_bf16_dpp v62, v80, v226 row_newbcast:8 row_mask:0xf bank_mask:0xf
    v_dot2c_f32_bf16_dpp v63, v80, v227 row_newbcast:8 row_mask:0xf bank_mask:0xf
    v_dot2c_f32_bf16_dpp v60, v80, v228 row_newbcast:9 row_mask:0xf bank_mask:0xf
    v_dot2c_f32_bf16_dpp v61, v80, v229 row_newbcast:9 row_mask:0xf bank_mask:0xf
    v_dot2c_f32_bf16_dpp v62, v80, v230 row_newbcast:9 row_mask:0xf bank_mask:0xf
    v_dot2c_f32_bf16_dpp v63, v80, v231 row_newbcast:9 row_mask:0xf bank_mask:0xf
    v_dot2c_f32_bf16_dpp v60, v80, v232 row_newbcast:10 row_mask:0xf bank_mask:0xf
    v_dot2c_f32_bf16_dpp v61, v80, v233 row_newbcast:10 row_mask:0xf bank_mask:0xf
    v_dot2c_f32_bf16_dpp v62, v80, v234 row_newbcast:10 row_mask:0xf bank_mask:0xf
    v_dot2c_f32_bf16_dpp v63, v80, v235 row_newbcast:10 row_mask:0xf bank_mask:0xf
    v_dot2c_f32_bf16_dpp v60, v80, v236 row_newbcast:11 row_mask:0xf bank_mask:0xf
    v_dot2c_f32_bf16_dpp v61, v80, v237 row_newbcast:11 row_mask:0xf bank_mask:0xf
    v_dot2c_f32_bf16_dpp v62, v80, v238 row_newbcast:11 row_mask:0xf bank_mask:0xf
    v_dot2c_f32_bf16_dpp v63, v80, v239 row_newbcast:11 row_mask:0xf bank_mask:0xf
    v_dot2c_f32_bf16_dpp v60, v80, v240 row_newbcast:12 row_mask:0xf bank_mask:0xf
    v_dot2c_f32_bf16_dpp v61, v80, v241 row_newbcast:12 row_mask:0xf bank_mask:0xf
    v_dot2c_f32_bf16_dpp v62, v80, v242 row_newbcast:12 row_mask:0xf bank_mask:0xf
    v_dot2c_f32_bf16_dpp v63, v80, v243 row_newbcast:12 row_mask:0xf bank_mask:0xf
    v_dot2c_f32_bf16_dpp v60, v80, v244 row_newbcast:13 row_mask:0xf bank_mask:0xf
    v_dot2c_f32_bf16_dpp v61, v80, v245 row_newbcast:13 row_mask:0xf bank_mask:0xf
    v_dot2c_f32_bf16_dpp v62, v80, v246 row_newbcast:13 row_mask:0xf bank_mask:0xf
    v_dot2c_f32_bf16_dpp v63, v80, v247 row_newbcast:13 row_mask:0xf bank_mask:0xf
    v_dot2c_f32_bf16_dpp v60, v80, v248 row_newbcast:14 row_mask:0xf bank_mask:0xf
    v_dot2c_f32_bf16_dpp v61, v80, v249 row_newbcast:14 row_mask:0xf bank_mask:0xf
    v_dot2c_f32_bf16_dpp v62, v80, v250 row_newbcast:14 row_mask:0xf bank_mask:0xf
    v_dot2c_f32_bf16_dpp v63, v80, v251 row_newbcast:14 row_mask:0xf bank_mask:0xf
    v_dot2c_f32_bf16_dpp v60, v80, v252 row_newbcast:15 row_mask:0xf bank_mask:0xf
    v_dot2c_f32_bf16_dpp v61, v80, v253 row_newbcast:15 row_mask:0xf bank_mask:0xf
    v_dot2c_f32_bf16_dpp v62, v80, v254 row_newbcast:15 row_mask:0xf bank_mask:0xf
    v_dot2c_f32_bf16_dpp v63, v80, v255 row_newbcast:15 row_mask:0xf bank_mask:0xf
    v_and_or_b32 v60, v60, s82, v3
    s_cbranch_execz Lx_171
    s_nop 0
    buffer_store_dwordx4 v[60:63], v9, s[44:47], s66 offen sc1
Lx_171:
    s_and_b32 s12, s4, 3
    s_cbranch_scc1 L_c_end
    s_lshl_b32 s67, s4, 13
    s_lshr_b32 s68, s8, 1
    s_lshl_b32 s68, s68, 14
    s_add_u32 s67, s67, s68
    s_and_b32 s68, s8, 1
    s_lshl_b32 s68, s68, 12
    s_add_u32 s67, s67, s68
    s_add_u32 s67, s67, s81
    s_add_u32 s68, s67, 1048576
    s_add_u32 s67, s67, 1048576
    v_and_b32 v108, 7, v0
    v_lshl_add_u32 v109, v108, 4, v1
    ds_read_b128 v[92:95], v109 offset:4096
    ds_read_b128 v[96:99], v109 offset:4224
    ds_read_b128 v[100:103], v109 offset:4352
    v_lshlrev_b32 v91, 3, v108
    v_lshlrev_b32 v89, 4, v108
    v_lshrrev_b32 v108, 3, v0
    v_lshl_add_u32 v108, v108, 13, v89
    v_mov_b32 v106, s6
    v_mov_b32 v107, s7
    v_mov_b32 v110, 1
    s_lshl_b32 s85, s4, 5
    s_add_u32 s86, s85, 524288
    s_getreg_b32 s84, hwreg(HW_REG_XCC_ID)
    s_and_b32 s84, s84, 3
    s_lshl_b32 s84, s84, 14
    s_add_u32 s84, s84, s81
    s_add_u32 s84, s84, 524288
    s_add_u32 s85, s85, s84
    s_lshl_b32 s87, s4, 4
    v_and_b32 v88, 31, v0
    v_lshlrev_b32 v88, 7, v88
    s_mov_b32 s56, s38
    s_mov_b32 s57, s39
    s_mov_b32 s58, 0x800
    s_mov_b32 s59, 0x20000
    s_waitcnt vmcnt(0) lgkmcnt(0)
    s_branch Lh_173
Lr_172:
    s_sub_u32 s5, s5, 16
    s_cbranch_scc1 L_done
Lh_173:
    s_cbranch_execz Lx_174
    buffer_load_dwordx4 v[64:67], v11, s[44:47], s67 offen offset:0 sc1
    buffer_load_dwordx4 v[68:71], v11, s[44:47], s67 offen offset:1024 sc1
    buffer_load_dwordx4 v[72:75], v11, s[44:47], s67 offen offset:2048 sc1
    buffer_load_dwordx4 v[76:79], v11, s[44:47], s67 offen offset:3072 sc1
Lx_174:
    s_waitcnt vmcnt(3)
    v_xor_b32 v64, v3, v64
    s_waitcnt vmcnt(2)
    v_xor_b32 v68, v3, v68
    v_or_b32 v84, v64, v68
    v_pk_add_f32 v[80:81], v[64:65], v[68:69]
    v_pk_add_f32 v[82:83], v[66:67], v[70:71]
    s_waitcnt vmcnt(1)
    v_xor_b32 v72, v3, v72
    v_or_b32 v84, v84, v72
    v_pk_add_f32 v[80:81], v[80:81], v[72:73]
    v_pk_add_f32 v[82:83], v[82:83], v[74:75]
    s_waitcnt vmcnt(0)
    v_xor_b32 v76, v3, v76
    v_or_b32 v84, v84, v76
    v_pk_add_f32 v[80:81], v[80:81], v[76:77]
    v_pk_add_f32 v[82:83], v[82:83], v[78:79]
    v_and_b32 v84, 0xff, v84
    v_cmp_ne_u32 vcc, 0, v84
    s_cbranch_vccnz Lr_172
    v_add_f32_dpp v80, v80, v80 row_ror:8 row_mask:0xf bank_mask:0xf
    v_add_f32_dpp v81, v81, v81 row_ror:8 row_mask:0xf bank_mask:0xf
    v_add_f32_dpp v82, v82, v82 row_ror:8 row_mask:0xf bank_mask:0xf
    v_add_f32_dpp v83, v83, v83 row_ror:8 row_mask:0xf bank_mask:0xf
    v_mov_b32 v84, v80
    v_mov_b32 v85, v81
    v_mov_b32 v86, v82
    v_mov_b32 v87, v83
    v_permlane16_swap_b32 v80, v84
    v_permlane16_swap_b32 v81, v85
    v_permlane16_swap_b32 v82, v86
    v_permlane16_swap_b32 v83, v87
    v_pk_add_f32 v[80:81], v[80:81], v[84:85]
    v_pk_add_f32 v[82:83], v[82:83], v[86:87]
    v_mov_b32 v84, v80
    v_mov_b32 v85, v81
    v_mov_b32 v86, v82
    v_mov_b32 v87, v83
    v_permlane32_swap_b32 v80, v84
    v_permlane32_swap_b32 v81, v85
    v_permlane32_swap_b32 v82, v86
    v_permlane32_swap_b32 v83, v87
    v_pk_add_f32 v[80:81], v[80:81], v[84:85]
    v_pk_add_f32 v[82:83], v[82:83], v[86:87]
    ds_write_b128 v10, v[80:83] offset:2304
    s_and_b64 exec, exec, 1
    ds_add_rtn_u32 v111, v1, v110 offset:80
    s_mov_b64 exec, s[100:101]
    ds_read_b128 v[112:115], v109 offset:2304
    ds_read_b128 v[116:119], v109 offset:2432
    ds_read_b128 v[120:123], v109 offset:2560
    ds_read_b128 v[124:127], v109 offset:2688
    s_waitcnt lgkmcnt(4)
    v_readfirstlane_b32 s12, v111
    s_cbranch_execz Lm_175
    s_cmp_lg_u32 s12, 3
    s_cbranch_scc1 L_c_x1d
Lm_175:
    s_waitcnt lgkmcnt(0)
    v_pk_add_f32 v[112:113], v[112:113], v[116:117]
    v_pk_add_f32 v[120:121], v[120:121], v[124:125]
    v_pk_add_f32 v[114:115], v[114:115], v[118:119]
    v_pk_add_f32 v[122:123], v[122:123], v[126:127]
    v_pk_add_f32 v[112:113], v[112:113], v[120:121]
    v_pk_add_f32 v[114:115], v[114:115], v[122:123]
    v_pk_fma_f32 v[112:113], v[112:113], v[92:93], v[96:97]
    v_pk_fma_f32 v[114:115], v[114:115], v[94:95], v[98:99]
    v_cvt_pk_bf16_f32 v104, v112, v113
    v_cvt_pk_bf16_f32 v105, v114, v115
    s_cbranch_execz Lx_176
    buffer_store_dwordx4 v[104:107], v108, s[44:47], s86 offen sc1
Lx_176:
    s_waitcnt vmcnt(0)
    ds_write_b32 v1, v110 offset:72
L_c_x1d:
    s_xor_b32 s12, s83, 0x40808080
    v_and_b32 v3, 3, v0
    v_lshlrev_b32 v3, 3, v3
    v_bfe_u32 v3, s12, v3, 8
    s_branch Lh_178
Lr_177:
    s_sub_u32 s5, s5, 1
    s_cbranch_scc1 L_done
Lh_178:
    ds_read_b32 v90, v1 offset:72
    s_waitcnt lgkmcnt(0)
    v_cmp_gt_u32 vcc, 1, v90
    s_cbranch_vccnz Lr_177
    s_branch Lh_180
Lr_179:
    s_sub_u32 s5, s5, 16
    s_cbranch_scc1 L_done
Lh_180:
    s_cbranch_execz Lx_181
    buffer_load_dwordx4 v[64:67], v88, s[44:47], s84 offen offset:0 sc1
    buffer_load_dwordx4 v[68:71], v89, s[44:47], s85 offen offset:0 sc1
Lx_181:
    s_waitcnt vmcnt(1)
    v_cmp_ne_u64 s[12:13], s[6:7], v[66:67]
    s_waitcnt vmcnt(0)
    v_cmp_ne_u64 vcc, s[6:7], v[70:71]
    s_nop 0
    s_or_b64 s[12:13], s[12:13], vcc
    s_cbranch_scc1 Lr_179
    v_lshlrev_b32 v96, 16, v68
    v_and_b32 v97, 0xffff0000, v68
    v_lshlrev_b32 v98, 16, v69
    v_and_b32 v99, 0xffff0000, v69
    s_cmp_eq_u32 s8, 3
    s_cbranch_scc1 L_c_e4b
    s_branch Lh_183
Lr_182:
    s_sub_u32 s5, s5, 16
    s_cbranch_scc1 L_done
Lh_183:
    s_cbranch_execz Lx_184
    buffer_load_dwordx4 v[64:67], v11, s[44:47], s68 offen offset:0 sc1
    buffer_load_dwordx4 v[68:71], v11, s[44:47], s68 offen offset:1024 sc1
    buffer_load_dwordx4 v[72:75], v11, s[44:47], s68 offen offset:2048 sc1
    buffer_load_dwordx4 v[76:79], v11, s[44:47], s68 offen offset:3072 sc1
Lx_184:
    s_waitcnt vmcnt(3)
    v_xor_b32 v64, v3, v64
    s_waitcnt vmcnt(2)
    v_xor_b32 v68, v3, v68
    v_or_b32 v84, v64, v68
    v_pk_add_f32 v[80:81], v[64:65], v[68:69]
    v_pk_add_f32 v[82:83], v[66:67], v[70:71]
    s_waitcnt vmcnt(1)
    v_xor_b32 v72, v3, v72
    v_or_b32 v84, v84, v72
    v_pk_add_f32 v[80:81], v[80:81], v[72:73]
    v_pk_add_f32 v[82:83], v[82:83], v[74:75]
    s_waitcnt vmcnt(0)
    v_xor_b32 v76, v3, v76
    v_or_b32 v84, v84, v76
    v_pk_add_f32 v[80:81], v[80:81], v[76:77]
    v_pk_add_f32 v[82:83], v[82:83], v[78:79]
    v_and_b32 v84, 0xff, v84
    v_cmp_ne_u32 vcc, 0, v84
    s_cbranch_vccnz Lr_182
    s_branch L_c_e4c
L_c_e4b:
    s_branch Lh_186
Lr_185:
    s_sub_u32 s5, s5, 16
    s_cbranch_scc1 L_done
Lh_186:
    s_cbranch_execz Lx_187
    buffer_load_dwordx4 v[64:67], v11, s[44:47], s68 offen offset:0 sc1
    buffer_load_dwordx4 v[68:71], v11, s[44:47], s68 offen offset:1024 sc1
Lx_187:
    s_waitcnt vmcnt(1)
    v_xor_b32 v64, v3, v64
    s_waitcnt vmcnt(0)
    v_xor_b32 v68, v3, v68
    v_or_b32 v84, v64, v68
    v_pk_add_f32 v[80:81], v[64:65], v[68:69]
    v_pk_add_f32 v[82:83], v[66:67], v[70:71]
    v_and_b32 v84, 0xff, v84
    v_cmp_ne_u32 vcc, 0, v84
    s_cbranch_vccnz Lr_185
L_c_e4c:
    s_nop 1
    v_add_f32_dpp v80, v80, v80 row_ror:8 row_mask:0xf bank_mask:0xf
    v_add_f32_dpp v81, v81, v81 row_ror:8 row_mask:0xf bank_mask:0xf
    v_add_f32_dpp v82, v82, v82 row_ror:8 row_mask:0xf bank_mask:0xf
    v_add_f32_dpp v83, v83, v83 row_ror:8 row_mask:0xf bank_mask:0xf
    v_mov_b32 v84, v80
    v_mov_b32 v85, v81
    v_mov_b32 v86, v82
    v_mov_b32 v87, v83
    v_permlane16_swap_b32 v80, v84
    v_permlane16_swap_b32 v81, v85
    v_permlane16_swap_b32 v82, v86
    v_permlane16_swap_b32 v83, v87
    v_pk_add_f32 v[80:81], v[80:81], v[84:85]
    v_pk_add_f32 v[82:83], v[82:83], v[86:87]
    v_mov_b32 v84, v80
    v_mov_b32 v85, v81
    v_mov_b32 v86, v82
    v_mov_b32 v87, v83
    v_permlane32_swap_b32 v80, v84
    v_permlane32_swap_b32 v81, v85
    v_permlane32_swap_b32 v82, v86
    v_permlane32_swap_b32 v83, v87
    v_pk_add_f32 v[80:81], v[80:81], v[84:85]
    v_pk_add_f32 v[82:83], v[82:83], v[86:87]
    ds_write_b128 v10, v[80:83] offset:2816
    s_and_b64 exec, exec, 1
    ds_add_rtn_u32 v111, v1, v110 offset:84
    s_mov_b64 exec, s[100:101]
    ds_read_b128 v[112:115], v109 offset:2816
    ds_read_b128 v[116:119], v109 offset:2944
    ds_read_b128 v[120:123], v109 offset:3072
    ds_read_b128 v[124:127], v109 offset:3200
    s_waitcnt lgkmcnt(4)
    v_readfirstlane_b32 s12, v111
    s_cbranch_execz Lm_188
    s_cmp_lg_u32 s12, 3
    s_cbranch_scc1 L_c_end
Lm_188:
    s_waitcnt lgkmcnt(0)
    v_pk_add_f32 v[112:113], v[112:113], v[116:117]
    v_pk_add_f32 v[120:121], v[120:121], v[124:125]
    v_pk_add_f32 v[114:115], v[114:115], v[118:119]
    v_pk_add_f32 v[122:123], v[122:123], v[126:127]
    v_pk_add_f32 v[112:113], v[112:113], v[120:121]
    v_pk_add_f32 v[114:115], v[114:115], v[122:123]
    v_pk_fma_f32 v[112:113], v[112:113], v[100:101], v[96:97]
    v_pk_fma_f32 v[114:115], v[114:115], v[102:103], v[98:99]
    v_cvt_pk_bf16_f32 v104, v112, v113
    v_cvt_pk_bf16_f32 v105, v114, v115
    s_cbranch_execz L_c_end
    s_mov_b64 exec, 0xff
    buffer_store_dwordx2 v[104:105], v91, s[56:59], s87 offen
    s_mov_b64 exec, 1
    s_cmp_lg_u32 s2, 0
    s_cbranch_scc1 L_c_outd
    buffer_store_dwordx2 v[106:107], v91, s[44:47], 0 offen sc1
L_c_outd:
    s_branch L_c_end
L_c_mlp:
    s_add_u32 s66, s66, 1048576
    v_lshl_add_u32 v10, v8, 5, v1
    s_xor_b32 s12, s83, 0x40808080
    v_and_b32 v3, 3, v0
    v_lshlrev_b32 v3, 3, v3
    v_bfe_u32 v3, s12, v3, 8
    v_add_u32 v12, v5, v1
    v_add_u32 v13, 8192, v4
    v_lshlrev_b32 v11, 4, v0
    s_getreg_b32 s84, hwreg(HW_REG_XCC_ID)
    s_and_b32 s84, s84, 3
    s_lshl_b32 s84, s84, 14
    s_add_u32 s84, s84, s81
    s_add_u32 s88, s84, 524288
    s_mov_b32 s89, 0x3f803f80
    s_add_u32 s84, s8, 0
    s_and_b32 s84, s84, 3
    s_lshl_b32 s84, s84, 10
    s_add_u32 s84, s84, s88
    s_add_u32 s85, s8, 1
    s_and_b32 s85, s85, 3
    s_lshl_b32 s85, s85, 10
    s_add_u32 s85, s85, s88
    s_add_u32 s86, s8, 2
    s_and_b32 s86, s86, 3
    s_lshl_b32 s86, s86, 10
    s_add_u32 s86, s86, s88
    s_add_u32 s87, s8, 3
    s_and_b32 s87, s87, 3
    s_lshl_b32 s87, s87, 10
    s_add_u32 s87, s87, s88
    s_branch Lh_190
Lr_189:
    s_sub_u32 s5, s5, 1
    s_cbranch_scc1 L_done
Lh_190:
    ds_read_b32 v14, v1 offset:64
    ds_read_b64 v[56:57], v12 offset:4096
    ds_read_b64 v[58:59], v12 offset:6144
    s_waitcnt lgkmcnt(2)
    v_cmp_gt_u32 vcc, 1, v14
    s_cbranch_vccnz Lr_189
    s_waitcnt lgkmcnt(0)
    v_lshlrev_b32 v48, 16, v56
    v_and_b32 v49, 0xffff0000, v56
    v_lshlrev_b32 v50, 16, v57
    v_and_b32 v51, 0xffff0000, v57
    v_lshlrev_b32 v52, 16, v58
    v_and_b32 v53, 0xffff0000, v58
    v_lshlrev_b32 v54, 16, v59
    v_and_b32 v55, 0xffff0000, v59
    v_add_f32 v52, 1.0, v52
    v_add_f32 v53, 1.0, v53
    v_add_f32 v54, 1.0, v54
    v_add_f32 v55, 1.0, v55
    v_cvt_pk_bf16_f32 v53, v52, v53
    v_cvt_pk_bf16_f32 v55, v54, v55
    v_lshlrev_b32 v52, 16, v53
    v_and_b32 v53, 0xffff0000, v53
    v_lshlrev_b32 v54, 16, v55
    v_and_b32 v55, 0xffff0000, v55
    v_lshrrev_b32 v12, 3, v0
    v_bfe_u32 v13, v0, 1, 1
    v_lshl_add_u32 v12, v12, 1, v13
    v_lshlrev_b32 v12, 5, v12
    v_and_b32 v13, 1, v0
    v_lshl_add_u32 v12, v13, 3, v12
    v_and_b32 v4, 4, v0
    s_lshl_b32 s12, s8, 9
    s_add_u32 s12, s12, 155648
    v_add3_u32 v4, v12, v4, s12
    v_lshlrev_b32 v8, 4, v13
    v_lshl_add_u32 v8, v7, 5, v8
    v_add_u32 v8, s12, v8
    v_mul_u32_u24 v7, 0xaaaa, v13
    v_add_u32 v7, 0x4444, v7
    v_mov_b32 v40, 0
    v_mov_b32 v41, 0
    v_mov_b32 v42, 0
    v_mov_b32 v43, 0
    v_mov_b32 v44, 0
    v_mov_b32 v45, 0
    v_mov_b32 v46, 0
    v_mov_b32 v47, 0
    v_mov_b32 v56, 0
    v_mov_b32 v57, 0
    v_mov_b32 v58, 0
    v_mov_b32 v59, 0
    v_mov_b32 v60, 0
    v_mov_b32 v61, 0
    v_mov_b32 v62, 0
    v_mov_b32 v63, 0
    v_add_u32 v13, s58, v5
    s_add_u32 s60, s60, 1
    s_add_u32 s58, s58, 16384
    s_cmp_eq_u32 s58, 147456
    s_cselect_b32 s58, 0, s58
    s_cmp_ge_u32 s61, s60
    s_cbranch_scc1 Lf_191
Lw_192:
    ds_read_b32 v14, v1 offset:0
    s_waitcnt lgkmcnt(0)
    v_readfirstlane_b32 s61, v14
    s_nop 0
    s_cmp_ge_u32 s61, s60
    s_cbranch_scc1 Ld_193
    s_cbranch_execz Ld_193
    s_sub_u32 s5, s5, 1
    s_cbranch_scc0 Lw_192
    s_branch L_done
Ld_193:
Lf_191:
    ds_read_b64 v[16:17], v13 offset:0
    ds_read_b64 v[18:19], v13 offset:2048
    ds_read_b64 v[20:21], v13 offset:4096
    ds_read_b64 v[22:23], v13 offset:6144
    ds_read_b64 v[24:25], v13 offset:8192
    ds_read_b64 v[26:27], v13 offset:10240
    ds_read_b64 v[28:29], v13 offset:12288
    ds_read_b64 v[30:31], v13 offset:14336
    s_waitcnt lgkmcnt(0)
    v_mov_b32 v14, s60
    ds_write_b32 v2, v14 offset:16
    v_perm_b32 v64, v18, v16, s70
    v_perm_b32 v65, v18, v16, s71
    v_perm_b32 v66, v19, v17, s70
    v_perm_b32 v67, v19, v17, s71
    v_perm_b32 v68, v22, v20, s70
    v_perm_b32 v69, v22, v20, s71
    v_perm_b32 v70, v23, v21, s70
    v_perm_b32 v71, v23, v21, s71
    v_perm_b32 v72, v26, v24, s70
    v_perm_b32 v73, v26, v24, s71
    v_perm_b32 v74, v27, v25, s70
    v_perm_b32 v75, v27, v25, s71
    v_perm_b32 v76, v30, v28, s70
    v_perm_b32 v77, v30, v28, s71
    v_perm_b32 v78, v31, v29, s70
    v_perm_b32 v79, v31, v29, s71
    v_add_u32 v13, s58, v5
    s_add_u32 s60, s60, 1
    s_add_u32 s58, s58, 16384
    s_cmp_eq_u32 s58, 147456
    s_cselect_b32 s58, 0, s58
    s_cmp_ge_u32 s61, s60
    s_cbranch_scc1 Lf_194
Lw_195:
    ds_read_b32 v14, v1 offset:0
    s_waitcnt lgkmcnt(0)
    v_readfirstlane_b32 s61, v14
    s_nop 0
    s_cmp_ge_u32 s61, s60
    s_cbranch_scc1 Ld_196
    s_cbranch_execz Ld_196
    s_sub_u32 s5, s5, 1
    s_cbranch_scc0 Lw_195
    s_branch L_done
Ld_196:
Lf_194:
    ds_read_b64 v[16:17], v13 offset:0
    ds_read_b64 v[18:19], v13 offset:2048
    ds_read_b64 v[20:21], v13 offset:4096
    ds_read_b64 v[22:23], v13 offset:6144
    ds_read_b64 v[24:25], v13 offset:8192
    ds_read_b64 v[26:27], v13 offset:10240
    ds_read_b64 v[28:29], v13 offset:12288
    ds_read_b64 v[30:31], v13 offset:14336
    s_waitcnt lgkmcnt(0)
    v_mov_b32 v14, s60
    ds_write_b32 v2, v14 offset:16
    v_perm_b32 v80, v18, v16, s70
    v_perm_b32 v81, v18, v16, s71
    v_perm_b32 v82, v19, v17, s70
    v_perm_b32 v83, v19, v17, s71
    v_perm_b32 v84, v22, v20, s70
    v_perm_b32 v85, v22, v20, s71
    v_perm_b32 v86, v23, v21, s70
    v_perm_b32 v87, v23, v21, s71
    v_perm_b32 v88, v26, v24, s70
    v_perm_b32 v89, v26, v24, s71
    v_perm_b32 v90, v27, v25, s70
    v_perm_b32 v91, v27, v25, s71
    v_perm_b32 v92, v30, v28, s70
    v_perm_b32 v93, v30, v28, s71
    v_perm_b32 v94, v31, v29, s70
    v_perm_b32 v95, v31, v29, s71
    v_add_u32 v13, s58, v5
    s_add_u32 s60, s60, 1
    s_add_u32 s58, s58, 16384
    s_cmp_eq_u32 s58, 147456
    s_cselect_b32 s58, 0, s58
    s_cmp_ge_u32 s61, s60
    s_cbranch_scc1 Lf_197
Lw_198:
    ds_read_b32 v14, v1 offset:0
    s_waitcnt lgkmcnt(0)
    v_readfirstlane_b32 s61, v14
    s_nop 0
    s_cmp_ge_u32 s61, s60
    s_cbranch_scc1 Ld_199
    s_cbranch_execz Ld_199
    s_sub_u32 s5, s5, 1
    s_cbranch_scc0 Lw_198
    s_branch L_done
Ld_199:
Lf_197:
    ds_read_b64 v[16:17], v13 offset:0
    ds_read_b64 v[18:19], v13 offset:2048
    ds_read_b64 v[20:21], v13 offset:4096
    ds_read_b64 v[22:23], v13 offset:6144
    ds_read_b64 v[24:25], v13 offset:8192
    ds_read_b64 v[26:27], v13 offset:10240
    ds_read_b64 v[28:29], v13 offset:12288
    ds_read_b64 v[30:31], v13 offset:14336
    s_waitcnt lgkmcnt(0)
    v_mov_b32 v14, s60
    ds_write_b32 v2, v14 offset:16
    v_perm_b32 v96, v18, v16, s70
    v_perm_b32 v97, v18, v16, s71
    v_perm_b32 v98, v19, v17, s70
    v_perm_b32 v99, v19, v17, s71
    v_perm_b32 v100, v22, v20, s70
    v_perm_b32 v101, v22, v20, s71
    v_perm_b32 v102, v23, v21, s70
    v_perm_b32 v103, v23, v21, s71
    v_perm_b32 v104, v26, v24, s70
    v_perm_b32 v105, v26, v24, s71
    v_perm_b32 v106, v27, v25, s70
    v_perm_b32 v107, v27, v25, s71
    v_perm_b32 v108, v30, v28, s70
    v_perm_b32 v109, v30, v28, s71
    v_perm_b32 v110, v31, v29, s70
    v_perm_b32 v111, v31, v29, s71
    v_add_u32 v13, s58, v5
    s_add_u32 s60, s60, 1
    s_add_u32 s58, s58, 16384
    s_cmp_eq_u32 s58, 147456
    s_cselect_b32 s58, 0, s58
    s_cmp_ge_u32 s61, s60
    s_cbranch_scc1 Lf_200
Lw_201:
    ds_read_b32 v14, v1 offset:0
    s_waitcnt lgkmcnt(0)
    v_readfirstlane_b32 s61, v14
    s_nop 0
    s_cmp_ge_u32 s61, s60
    s_cbranch_scc1 Ld_202
    s_cbranch_execz Ld_202
    s_sub_u32 s5, s5, 1
    s_cbranch_scc0 Lw_201
    s_branch L_done
Ld_202:
Lf_200:
    ds_read_b64 v[16:17], v13 offset:0
    ds_read_b64 v[18:19], v13 offset:2048
    ds_read_b64 v[20:21], v13 offset:4096
    ds_read_b64 v[22:23], v13 offset:6144
    ds_read_b64 v[24:25], v13 offset:8192
    ds_read_b64 v[26:27], v13 offset:10240
    ds_read_b64 v[28:29], v13 offset:12288
    ds_read_b64 v[30:31], v13 offset:14336
    s_waitcnt lgkmcnt(0)
    v_mov_b32 v14, s60
    ds_write_b32 v2, v14 offset:16
    v_perm_b32 v112, v18, v16, s70
    v_perm_b32 v113, v18, v16, s71
    v_perm_b32 v114, v19, v17, s70
    v_perm_b32 v115, v19, v17, s71
    v_perm_b32 v116, v22, v20, s70
    v_perm_b32 v117, v22, v20, s71
    v_perm_b32 v118, v23, v21, s70
    v_perm_b32 v119, v23, v21, s71
    v_perm_b32 v120, v26, v24, s70
    v_perm_b32 v121, v26, v24, s71
    v_perm_b32 v122, v27, v25, s70
    v_perm_b32 v123, v27, v25, s71
    v_perm_b32 v124, v30, v28, s70
    v_perm_b32 v125, v30, v28, s71
    v_perm_b32 v126, v31, v29, s70
    v_perm_b32 v127, v31, v29, s71
    s_branch L_c_x1h
L_c_x1r:
    s_sub_u32 s5, s5, 16
    s_cbranch_scc1 L_done
L_c_x1h:
    s_cbranch_execz Lx_203
    buffer_load_dwordx4 v[16:19], v11, s[44:47], s84 offen sc1
    buffer_load_dwordx4 v[20:23], v11, s[44:47], s85 offen sc1
    buffer_load_dwordx4 v[24:27], v11, s[44:47], s86 offen sc1
    buffer_load_dwordx4 v[28:31], v11, s[44:47], s87 offen sc1
Lx_203:
    s_waitcnt vmcnt(3)
    v_cmp_ne_u64 s[12:13], s[6:7], v[18:19]
    v_dot2_f32_bf16 v32, v16, s89, 0
    v_dot2_f32_bf16 v33, v16, v16, 0
    v_dot2_f32_bf16 v32, v17, s89, v32
    v_dot2_f32_bf16 v33, v17, v17, v33
    s_waitcnt vmcnt(2)
    v_cmp_ne_u64 vcc, s[6:7], v[22:23]
    v_dot2_f32_bf16 v32, v20, s89, v32
    v_dot2_f32_bf16 v33, v20, v20, v33
    v_dot2_f32_bf16 v32, v21, s89, v32
    v_dot2_f32_bf16 v33, v21, v21, v33
    s_or_b64 s[12:13], s[12:13], vcc
    s_waitcnt vmcnt(1)
    v_cmp_ne_u64 vcc, s[6:7], v[26:27]
    v_dot2_f32_bf16 v32, v24, s89, v32
    v_dot2_f32_bf16 v33, v24, v24, v33
    v_dot2_f32_bf16 v32, v25, s89, v32
    v_dot2_f32_bf16 v33, v25, v25, v33
    s_or_b64 s[12:13], s[12:13], vcc
    s_waitcnt vmcnt(0)
    v_cmp_ne_u64 vcc, s[6:7], v[30:31]
    v_dot2_f32_bf16 v32, v28, s89, v32
    v_dot2_f32_bf16 v33, v28, v28, v33
    v_dot2_f32_bf16 v32, v29, s89, v32
    v_dot2_f32_bf16 v33, v29, v29, v33
    s_or_b64 s[12:13], s[12:13], vcc
    s_cbranch_scc1 L_c_x1r
    v_lshlrev_b32 v36, 16, v16
    v_add_f32_dpp v32, v32, v32 quad_perm:[1,0,3,2] row_mask:0xf bank_mask:0xf
    v_add_f32_dpp v33, v33, v33 quad_perm:[1,0,3,2] row_mask:0xf bank_mask:0xf
    v_and_b32 v37, 0xffff0000, v16
    v_add_f32_dpp v32, v32, v32 quad_perm:[2,3,0,1] row_mask:0xf bank_mask:0xf
    v_add_f32_dpp v33, v33, v33 quad_perm:[2,3,0,1] row_mask:0xf bank_mask:0xf
    v_lshlrev_b32 v38, 16, v17
    v_add_f32_dpp v32, v32, v32 row_half_mirror row_mask:0xf bank_mask:0xf
    v_add_f32_dpp v33, v33, v33 row_half_mirror row_mask:0xf bank_mask:0xf
    v_and_b32 v39, 0xffff0000, v17
    v_add_f32_dpp v32, v32, v32 row_mirror row_mask:0xf bank_mask:0xf
    v_add_f32_dpp v33, v33, v33 row_mirror row_mask:0xf bank_mask:0xf
    v_mov_b32 v34, v32
    v_mov_b32 v35, v33
    v_pk_mul_f32 v[36:37], v[36:37], v[52:53]
    v_permlane16_swap_b32 v32, v34
    v_permlane16_swap_b32 v33, v35
    v_pk_add_f32 v[32:33], v[32:33], v[34:35]
    v_mov_b32 v34, v32
    v_mov_b32 v35, v33
    v_pk_mul_f32 v[38:39], v[38:39], v[54:55]
    v_permlane32_swap_b32 v32, v34
    v_permlane32_swap_b32 v33, v35
    v_pk_add_f32 v[32:33], v[32:33], v[34:35]
    v_mov_b32 v34, 0x3727c5ac
    v_mul_f32 v32, 0x3a800000, v32
    v_fmac_f32 v34, 0x3a800000, v33
    v_pk_fma_f32 v[36:37], v[52:53], v[32:33], v[36:37] op_sel_hi:[1,0,1] neg_lo:[1,0,0] neg_hi:[1,0,0]
    v_fma_f32 v34, -v32, v32, v34
    v_pk_fma_f32 v[38:39], v[54:55], v[32:33], v[38:39] op_sel_hi:[1,0,1] neg_lo:[1,0,0] neg_hi:[1,0,0]
    v_max_f32 v34, 0x3727c5ac, v34
    v_rsq_f32 v34, v34
    s_nop 0
    v_pk_fma_f32 v[36:37], v[36:37], v[34:35], v[48:49] op_sel_hi:[1,0,1]
    v_pk_fma_f32 v[38:39], v[38:39], v[34:35], v[50:51] op_sel_hi:[1,0,1]
    v_cvt_pk_bf16_f32 v36, v36, v37
    v_cvt_pk_bf16_f32 v37, v38, v39
    ds_write2_b32 v4, v36, v37 offset0:0 offset1:4
    ds_read_b128 v[16:19], v8 offset:0
    ds_read_b128 v[20:23], v8 offset:128
    ds_read_b128 v[24:27], v8 offset:256
    ds_read_b128 v[28:31], v8 offset:384
    v_mov_b32 v14, 1
    s_waitcnt lgkmcnt(3)
    v_smfmac_f32_16x16x64_bf16 v[40:43], v[16:19], v[128:135], v7
    v_smfmac_f32_16x16x64_bf16 v[44:47], v[16:19], v[160:167], v7
    v_smfmac_f32_16x16x64_bf16 v[56:59], v[16:19], v[192:199], v7
    v_smfmac_f32_16x16x64_bf16 v[60:63], v[16:19], v[224:231], v7
    s_waitcnt lgkmcnt(2)
    v_smfmac_f32_16x16x64_bf16 v[40:43], v[20:23], v[136:143], v7
    v_smfmac_f32_16x16x64_bf16 v[44:47], v[20:23], v[168:175], v7
    v_smfmac_f32_16x16x64_bf16 v[56:59], v[20:23], v[200:207], v7
    v_smfmac_f32_16x16x64_bf16 v[60:63], v[20:23], v[232:239], v7
    s_waitcnt lgkmcnt(1)
    v_smfmac_f32_16x16x64_bf16 v[40:43], v[24:27], v[144:151], v7
    v_smfmac_f32_16x16x64_bf16 v[44:47], v[24:27], v[176:183], v7
    v_smfmac_f32_16x16x64_bf16 v[56:59], v[24:27], v[208:215], v7
    v_smfmac_f32_16x16x64_bf16 v[60:63], v[24:27], v[240:247], v7
    s_waitcnt lgkmcnt(0)
    v_smfmac_f32_16x16x64_bf16 v[40:43], v[28:31], v[152:159], v7
    v_smfmac_f32_16x16x64_bf16 v[44:47], v[28:31], v[184:191], v7
    v_smfmac_f32_16x16x64_bf16 v[56:59], v[28:31], v[216:223], v7
    v_smfmac_f32_16x16x64_bf16 v[60:63], v[28:31], v[248:255], v7
    s_nop 4
    v_add_f32 v32, v40, v41
    ds_write_b32 v6, v32 offset:256
    v_add_f32 v33, v44, v45
    ds_write_b32 v6, v33 offset:512
    v_add_f32 v34, v56, v57
    ds_write_b32 v6, v34 offset:768
    v_add_f32 v35, v60, v61
    ds_write_b32 v6, v35 offset:1024
    ds_write_b32 v2, v14 offset:32
    v_mov_b32 v44, 0
    v_mov_b32 v45, 0
    v_mov_b32 v46, 0
    v_mov_b32 v47, 0
    v_mov_b32 v38, 0xbdd2d3e8
    s_branch Lh_205
Lr_204:
    s_sub_u32 s5, s5, 1
    s_cbranch_scc1 L_done
Lh_205:
    ds_read_b128 v[40:43], v1 offset:32
    ds_read_b128 v[16:19], v10 offset:256
    ds_read_b128 v[20:23], v10 offset:272
    ds_read_b128 v[24:27], v10 offset:768
    ds_read_b128 v[28:31], v10 offset:784
    s_waitcnt lgkmcnt(4)
    v_min3_u32 v40, v40, v41, v42
    v_min_u32 v40, v40, v43
    v_cmp_gt_u32 vcc, 1, v40
    s_cbranch_vccnz Lr_204
    s_waitcnt lgkmcnt(0)
    v_pk_add_f32 v[16:17], v[16:17], v[18:19]
    v_pk_add_f32 v[20:21], v[20:21], v[22:23]
    v_pk_add_f32 v[24:25], v[24:25], v[26:27]
    v_pk_add_f32 v[28:29], v[28:29], v[30:31]
    v_add_f32 v32, v16, v17
    v_add_f32 v33, v20, v21
    v_add_f32 v34, v24, v25
    v_add_f32 v35, v28, v29
    v_pk_mul_f32 v[36:37], v[32:33], v[32:33]
    v_pk_mul_f32 v[34:35], v[32:33], v[34:35]
    v_fmaak_f32 v36, v38, v36, 0xc0135761
    v_fmaak_f32 v37, v38, v37, 0xc0135761
    v_pk_mul_f32 v[36:37], v[36:37], v[32:33]
    v_exp_f32 v36, v36
    v_exp_f32 v37, v37
    v_add_f32 v36, 1.0, v36
    v_add_f32 v37, 1.0, v37
    v_rcp_f32 v36, v36
    v_rcp_f32 v37, v37
    s_nop 0
    v_pk_mul_f32 v[32:33], v[34:35], v[36:37]
    v_cvt_pk_bf16_f32 v32, v32, v33
    s_nop 1
    v_dot2c_f32_bf16_dpp v44, v32, v64 row_newbcast:0 row_mask:0xf bank_mask:0xf
    v_dot2c_f32_bf16_dpp v45, v32, v65 row_newbcast:0 row_mask:0xf bank_mask:0xf
    v_dot2c_f32_bf16_dpp v46, v32, v66 row_newbcast:0 row_mask:0xf bank_mask:0xf
    v_dot2c_f32_bf16_dpp v47, v32, v67 row_newbcast:0 row_mask:0xf bank_mask:0xf
    v_dot2c_f32_bf16_dpp v44, v32, v68 row_newbcast:1 row_mask:0xf bank_mask:0xf
    v_dot2c_f32_bf16_dpp v45, v32, v69 row_newbcast:1 row_mask:0xf bank_mask:0xf
    v_dot2c_f32_bf16_dpp v46, v32, v70 row_newbcast:1 row_mask:0xf bank_mask:0xf
    v_dot2c_f32_bf16_dpp v47, v32, v71 row_newbcast:1 row_mask:0xf bank_mask:0xf
    v_dot2c_f32_bf16_dpp v44, v32, v72 row_newbcast:2 row_mask:0xf bank_mask:0xf
    v_dot2c_f32_bf16_dpp v45, v32, v73 row_newbcast:2 row_mask:0xf bank_mask:0xf
    v_dot2c_f32_bf16_dpp v46, v32, v74 row_newbcast:2 row_mask:0xf bank_mask:0xf
    v_dot2c_f32_bf16_dpp v47, v32, v75 row_newbcast:2 row_mask:0xf bank_mask:0xf
    v_dot2c_f32_bf16_dpp v44, v32, v76 row_newbcast:3 row_mask:0xf bank_mask:0xf
    v_dot2c_f32_bf16_dpp v45, v32, v77 row_newbcast:3 row_mask:0xf bank_mask:0xf
    v_dot2c_f32_bf16_dpp v46, v32, v78 row_newbcast:3 row_mask:0xf bank_mask:0xf
    v_dot2c_f32_bf16_dpp v47, v32, v79 row_newbcast:3 row_mask:0xf bank_mask:0xf
    v_dot2c_f32_bf16_dpp v44, v32, v80 row_newbcast:4 row_mask:0xf bank_mask:0xf
    v_dot2c_f32_bf16_dpp v45, v32, v81 row_newbcast:4 row_mask:0xf bank_mask:0xf
    v_dot2c_f32_bf16_dpp v46, v32, v82 row_newbcast:4 row_mask:0xf bank_mask:0xf
    v_dot2c_f32_bf16_dpp v47, v32, v83 row_newbcast:4 row_mask:0xf bank_mask:0xf
    v_dot2c_f32_bf16_dpp v44, v32, v84 row_newbcast:5 row_mask:0xf bank_mask:0xf
    v_dot2c_f32_bf16_dpp v45, v32, v85 row_newbcast:5 row_mask:0xf bank_mask:0xf
    v_dot2c_f32_bf16_dpp v46, v32, v86 row_newbcast:5 row_mask:0xf bank_mask:0xf
    v_dot2c_f32_bf16_dpp v47, v32, v87 row_newbcast:5 row_mask:0xf bank_mask:0xf
    v_dot2c_f32_bf16_dpp v44, v32, v88 row_newbcast:6 row_mask:0xf bank_mask:0xf
    v_dot2c_f32_bf16_dpp v45, v32, v89 row_newbcast:6 row_mask:0xf bank_mask:0xf
    v_dot2c_f32_bf16_dpp v46, v32, v90 row_newbcast:6 row_mask:0xf bank_mask:0xf
    v_dot2c_f32_bf16_dpp v47, v32, v91 row_newbcast:6 row_mask:0xf bank_mask:0xf
    v_dot2c_f32_bf16_dpp v44, v32, v92 row_newbcast:7 row_mask:0xf bank_mask:0xf
    v_dot2c_f32_bf16_dpp v45, v32, v93 row_newbcast:7 row_mask:0xf bank_mask:0xf
    v_dot2c_f32_bf16_dpp v46, v32, v94 row_newbcast:7 row_mask:0xf bank_mask:0xf
    v_dot2c_f32_bf16_dpp v47, v32, v95 row_newbcast:7 row_mask:0xf bank_mask:0xf
    v_dot2c_f32_bf16_dpp v44, v32, v96 row_newbcast:8 row_mask:0xf bank_mask:0xf
    v_dot2c_f32_bf16_dpp v45, v32, v97 row_newbcast:8 row_mask:0xf bank_mask:0xf
    v_dot2c_f32_bf16_dpp v46, v32, v98 row_newbcast:8 row_mask:0xf bank_mask:0xf
    v_dot2c_f32_bf16_dpp v47, v32, v99 row_newbcast:8 row_mask:0xf bank_mask:0xf
    v_dot2c_f32_bf16_dpp v44, v32, v100 row_newbcast:9 row_mask:0xf bank_mask:0xf
    v_dot2c_f32_bf16_dpp v45, v32, v101 row_newbcast:9 row_mask:0xf bank_mask:0xf
    v_dot2c_f32_bf16_dpp v46, v32, v102 row_newbcast:9 row_mask:0xf bank_mask:0xf
    v_dot2c_f32_bf16_dpp v47, v32, v103 row_newbcast:9 row_mask:0xf bank_mask:0xf
    v_dot2c_f32_bf16_dpp v44, v32, v104 row_newbcast:10 row_mask:0xf bank_mask:0xf
    v_dot2c_f32_bf16_dpp v45, v32, v105 row_newbcast:10 row_mask:0xf bank_mask:0xf
    v_dot2c_f32_bf16_dpp v46, v32, v106 row_newbcast:10 row_mask:0xf bank_mask:0xf
    v_dot2c_f32_bf16_dpp v47, v32, v107 row_newbcast:10 row_mask:0xf bank_mask:0xf
    v_dot2c_f32_bf16_dpp v44, v32, v108 row_newbcast:11 row_mask:0xf bank_mask:0xf
    v_dot2c_f32_bf16_dpp v45, v32, v109 row_newbcast:11 row_mask:0xf bank_mask:0xf
    v_dot2c_f32_bf16_dpp v46, v32, v110 row_newbcast:11 row_mask:0xf bank_mask:0xf
    v_dot2c_f32_bf16_dpp v47, v32, v111 row_newbcast:11 row_mask:0xf bank_mask:0xf
    v_dot2c_f32_bf16_dpp v44, v32, v112 row_newbcast:12 row_mask:0xf bank_mask:0xf
    v_dot2c_f32_bf16_dpp v45, v32, v113 row_newbcast:12 row_mask:0xf bank_mask:0xf
    v_dot2c_f32_bf16_dpp v46, v32, v114 row_newbcast:12 row_mask:0xf bank_mask:0xf
    v_dot2c_f32_bf16_dpp v47, v32, v115 row_newbcast:12 row_mask:0xf bank_mask:0xf
    v_dot2c_f32_bf16_dpp v44, v32, v116 row_newbcast:13 row_mask:0xf bank_mask:0xf
    v_dot2c_f32_bf16_dpp v45, v32, v117 row_newbcast:13 row_mask:0xf bank_mask:0xf
    v_dot2c_f32_bf16_dpp v46, v32, v118 row_newbcast:13 row_mask:0xf bank_mask:0xf
    v_dot2c_f32_bf16_dpp v47, v32, v119 row_newbcast:13 row_mask:0xf bank_mask:0xf
    v_dot2c_f32_bf16_dpp v44, v32, v120 row_newbcast:14 row_mask:0xf bank_mask:0xf
    v_dot2c_f32_bf16_dpp v45, v32, v121 row_newbcast:14 row_mask:0xf bank_mask:0xf
    v_dot2c_f32_bf16_dpp v46, v32, v122 row_newbcast:14 row_mask:0xf bank_mask:0xf
    v_dot2c_f32_bf16_dpp v47, v32, v123 row_newbcast:14 row_mask:0xf bank_mask:0xf
    v_dot2c_f32_bf16_dpp v44, v32, v124 row_newbcast:15 row_mask:0xf bank_mask:0xf
    v_dot2c_f32_bf16_dpp v45, v32, v125 row_newbcast:15 row_mask:0xf bank_mask:0xf
    v_dot2c_f32_bf16_dpp v46, v32, v126 row_newbcast:15 row_mask:0xf bank_mask:0xf
    v_dot2c_f32_bf16_dpp v47, v32, v127 row_newbcast:15 row_mask:0xf bank_mask:0xf
    v_and_or_b32 v44, v44, s82, v3
    s_cbranch_execz Lx_206
    s_nop 0
    buffer_store_dwordx4 v[44:47], v9, s[44:47], s66 offen sc1
Lx_206:
L_c_end:
    s_cbranch_execnz L_c_real
    s_cmp_eq_u32 s9, 0
    s_cbranch_scc1 L_c_dryB_ret
    s_branch L_c_dryA_ret
L_c_real:
    s_endpgm
L_done:
    s_endpgm
.section .rodata,"a"
.p2align 6
.amdhsa_kernel adaLN_cond__gqa_block_cached__glu_gated_geglu__decode_kernel
  .amdhsa_next_free_vgpr 256
  .amdhsa_next_free_sgpr 102
  .amdhsa_accum_offset 256
  .amdhsa_group_segment_fixed_size 0
  .amdhsa_kernarg_size 112
  .amdhsa_user_sgpr_count 2
  .amdhsa_user_sgpr_kernarg_segment_ptr 1
  .amdhsa_system_sgpr_workgroup_id_x 1
  .amdhsa_float_denorm_mode_32 3
.end_amdhsa_kernel
```
